```python
import torch

def _softmax(x, axis=-1):
    return torch.softmax(x, dim=axis)
def _gelu(x):
    return torch.nn.functional.gelu(x, approximate="tanh")
def _silu(x):
    return torch.nn.functional.silu(x)
def _sigmoid(x):
    return torch.sigmoid(x)
def _layernorm(x, axis=-1, eps=1e-5):
    m = x.mean(dim=axis, keepdim=True)
    v = x.var(dim=axis, keepdim=True, unbiased=False)
    return (x - m) / torch.sqrt(v + eps)
def _scatter_add(tgt, idx, src, axis=0):
    return tgt.clone().index_add_(axis, idx, src)
def _segment_sum(src, seg, n):
    out = torch.zeros((n,) + src.shape[1:], dtype=src.dtype)
    return out.index_add_(0, seg, src)
def _pad(x, pw):
    flat = tuple(v for pair in reversed(pw) for v in pair)
    return torch.nn.functional.pad(x, flat)

kernel_name = 'interleave_layers__sliding_block_cached__sliding_block_cached__decode'

def setup_inputs():

    _w = (lambda a: (lambda t: t.to(torch.bfloat16) if t.is_floating_point() else t)(torch.as_tensor(a)))
    def _A_setup():
        B, Sq, D = 4, 1, 512
        Hq, Hkv, Sk, Dh = 32, 8, 4096, 128
        assert Hq % Hkv == 0, (Hq, Hkv)
        return {
            "x": _w((lambda *s: torch.randn(*s, dtype=torch.bfloat16) * 0.05)(B, Sq, D)),
            "k_cache": _w((lambda *s: torch.randn(*s, dtype=torch.bfloat16) * 0.8)(B, Hkv, Sk, Dh)),
            "v_cache": _w((lambda *s: torch.randn(*s, dtype=torch.bfloat16) * 3.2)(B, Hkv, Sk, Dh)),
            "wq": _w((lambda *s: torch.randn(*s, dtype=torch.bfloat16) * 0.8)(D, Hq * Dh) * (D ** -0.5)),
            "wo": _w((lambda *s: torch.randn(*s, dtype=torch.bfloat16) * 3.2)(Hq * Dh, D) * ((Hq * Dh) ** -0.5)),
        }
    _A_in = _A_setup()

    def _B_setup():
        B, Sq, D = 4, 1, 512
        Hq, Hkv, Sk, Dh = 32, 8, 4096, 128
        assert Hq % Hkv == 0, (Hq, Hkv)
        return {
            "x": _w((lambda *s: torch.randn(*s, dtype=torch.bfloat16) * 0.05)(B, Sq, D)),
            "k_cache": _w((lambda *s: torch.randn(*s, dtype=torch.bfloat16) * 1.6)(B, Hkv, Sk, Dh)),
            "v_cache": _w((lambda *s: torch.randn(*s, dtype=torch.bfloat16) * 1.6)(B, Hkv, Sk, Dh)),
            "wq": _w((lambda *s: torch.randn(*s, dtype=torch.bfloat16) * 1.6)(D, Hq * Dh) * (D ** -0.5)),
            "wo": _w((lambda *s: torch.randn(*s, dtype=torch.bfloat16) * 1.6)(Hq * Dh, D) * ((Hq * Dh) ** -0.5)),
        }
    _B_in = _B_setup()

    return {
        "A_x": _A_in["x"],
        "A_k_cache": _A_in["k_cache"],
        "A_v_cache": _A_in["v_cache"],
        "A_wq": _A_in["wq"],
        "A_wo": _A_in["wo"],
        "B_x": _B_in["x"],
        "B_k_cache": _B_in["k_cache"],
        "B_v_cache": _B_in["v_cache"],
        "B_wq": _B_in["wq"],
        "B_wo": _B_in["wo"],
    }

def reference(A_x, A_k_cache, A_v_cache, A_wq, A_wo, B_x, B_k_cache, B_v_cache, B_wq, B_wo):
    def _A_ref(x, k_cache, v_cache, wq, wo):
        B, Sq, D = x.shape
        Hq, Dh = 32, 128
        Hkv, Sk = k_cache.shape[1], k_cache.shape[2]
        W = min(4096, max(256, Sk // 4))
        rep = Hq // Hkv
        q = (lambda x, *d: x.permute(*d))((x @ wq).reshape(B, Sq, Hq, Dh), 0, 2, 1, 3)
        k = (lambda x, n, axis: torch.repeat_interleave(x, n, dim=axis))(k_cache[:, :, Sk - W:, :], rep, axis=1)
        v = (lambda x, n, axis: torch.repeat_interleave(x, n, dim=axis))(v_cache[:, :, Sk - W:, :], rep, axis=1)
        scores = torch.einsum("bhqd,bhkd->bhqk", q, k) * (Dh ** -0.5)
        p = _softmax(scores, axis=-1)
        o = torch.einsum("bhqk,bhkd->bhqd", p, v)
        return (lambda x, *d: x.permute(*d))(o, 0, 2, 1, 3).reshape(B, Sq, Hq * Dh) @ wo

    def _B_ref(x, k_cache, v_cache, wq, wo):
        B, Sq, D = x.shape
        Hq, Dh = 32, 128
        Hkv, Sk = k_cache.shape[1], k_cache.shape[2]
        W = min(4096, max(256, Sk // 4))
        rep = Hq // Hkv
        q = (lambda x, *d: x.permute(*d))((x @ wq).reshape(B, Sq, Hq, Dh), 0, 2, 1, 3)
        k = (lambda x, n, axis: torch.repeat_interleave(x, n, dim=axis))(k_cache[:, :, Sk - W:, :], rep, axis=1)
        v = (lambda x, n, axis: torch.repeat_interleave(x, n, dim=axis))(v_cache[:, :, Sk - W:, :], rep, axis=1)
        scores = torch.einsum("bhqd,bhkd->bhqk", q, k) * (Dh ** -0.5)
        p = _softmax(scores, axis=-1)
        o = torch.einsum("bhqk,bhkd->bhqd", p, v)
        return (lambda x, *d: x.permute(*d))(o, 0, 2, 1, 3).reshape(B, Sq, Hq * Dh) @ wo

    x = A_x
    x = x + _A_ref(_layernorm(x, axis=-1), A_k_cache, A_v_cache, A_wq, A_wo)
    x = x + _B_ref(_layernorm(x, axis=-1), B_k_cache, B_v_cache, B_wq, B_wo)
    x = x + _A_ref(_layernorm(x, axis=-1), A_k_cache, A_v_cache, A_wq, A_wo)
    x = x + _B_ref(_layernorm(x, axis=-1), B_k_cache, B_v_cache, B_wq, B_wo)
    return x
```

```asm
; @launch grid=(256,1,1) block=(1024,1,1) lds=147456
.amdgcn_target "amdgcn-amd-amdhsa--gfx950"
.text
.globl interleave_layers__sliding_block_cached__sliding_block_cached__decode_kernel
.p2align 8
.type interleave_layers__sliding_block_cached__sliding_block_cached__decode_kernel,@function
interleave_layers__sliding_block_cached__sliding_block_cached__decode_kernel:
    s_cmp_ge_u32 s2, 256
    s_cbranch_scc1 L_exit
    s_load_dwordx16 s[16:31], s[0:1], 0
    s_load_dwordx8 s[32:39], s[0:1], 64
    s_load_dwordx2 s[40:41], s[0:1], 96
    v_and_b32 v1, 63, v0
    v_lshrrev_b32 v2, 6, v0
    s_and_b32 s48, s2, 7
    v_readfirstlane_b32 s58, v2
    v_lshlrev_b32 v4, 4, v1
    v_and_b32 v2, 15, v1
    v_lshrrev_b32 v3, 4, v1
    s_lshr_b32 s73, s2, 4
    v_mov_b32 v13, 0
    v_lshlrev_b32 v5, 2, v1
    s_and_b32 s42, s58, 3
    s_lshr_b32 s43, s58, 2
    s_lshr_b32 s49, s2, 3
    s_and_b32 s3, s49, 1
    s_mov_b32 s52, 0x10000
    s_mov_b32 s53, 0x05040100
    s_mov_b32 s54, 0x07060302
    s_mov_b32 s55, 0
    s_mov_b32 s50, 1
    s_lshl_b32 s56, s42, 2
    v_mov_b32 v14, s56
    s_lshl_b32 s56, s3, 2
    s_add_u32 s56, s56, s43
    s_cmp_lt_u32 s56, 2
    s_cbranch_scc1 L_PQ
    s_cmp_lt_u32 s43, 2
    s_cbranch_scc1 L_ATT
    s_cmp_lg_u32 s58, 8
    s_cbranch_scc1 L_noinit
    ds_write_b32 v5, v13
    ds_write_b32 v5, v13 offset:256
L_noinit:
    s_waitcnt lgkmcnt(0)
    s_barrier
    s_mov_b32 s4, s40
    s_mov_b32 s5, s41
    s_mov_b32 s6, 0x400000
    s_mov_b32 s7, 0x00020000
    s_cmp_eq_u32 s58, 13
    s_cbranch_scc1 L_HS
L_roles:
    s_lshl_b32 s56, s3, 2
    s_add_u32 s56, s56, s43
    s_cmp_lt_u32 s56, 4
    s_cbranch_scc1 L_PO
L_ATT:
    s_and_b32 s71, s43, 1
    s_lshr_b32 s51, s43, 1
    s_lshl_b32 s67, s73, 1
    s_add_u32 s67, s67, s71
    s_add_u32 s50, s51, 1
    s_lshr_b32 s58, s67, 3
    s_and_b32 s59, s67, 7
    s_lshl_b32 s56, s58, 23
    s_lshl_b32 s57, s48, 20
    s_add_u32 s56, s56, s57
    s_lshl_b32 s57, s59, 15
    s_add_u32 s56, s56, s57
    s_lshl_b32 s57, s42, 13
    s_add_u32 s56, s56, s57
    s_add_u32 s64, s56, 0xc0000
    s_add_u32 s69, s64, 4096
    v_lshlrev_b32 v16, 4, v2
    v_lshl_add_u32 v8, v3, 10, v16
    v_mov_b32 v18, 1
    s_lshl_b32 s56, s71, 4
    v_add_u32 v19, s56, v14
    s_cmp_lg_u32 s51, 0
    s_cbranch_scc1 L_att_sb
    s_mov_b32 s14, 0x2000000
    s_mov_b32 s15, 0x00020000
    s_waitcnt lgkmcnt(0)
    s_mov_b64 s[12:13], s[20:21]
    buffer_load_dwordx4 v[52:55], v8, s[12:15], s64 offen offset:0 nt
    buffer_load_dwordx4 v[56:59], v8, s[12:15], s64 offen offset:256 nt
    buffer_load_dwordx4 v[60:63], v8, s[12:15], s64 offen offset:512 nt
    buffer_load_dwordx4 v[64:67], v8, s[12:15], s64 offen offset:768 nt
    s_mov_b32 s8, s18
    s_mov_b32 s9, s19
    s_mov_b32 s10, 0x2000000
    s_mov_b32 s11, 0x00020000
    s_mov_b32 s4, s40
    s_mov_b32 s5, s41
    s_mov_b32 s6, 0x400000
    s_mov_b32 s7, 0x00020000
    s_barrier
    s_waitcnt vmcnt(3)
    buffer_load_dwordx4 v[68:71], v8, s[12:15], s69 offen offset:0 nt
    s_waitcnt vmcnt(3)
    buffer_load_dwordx4 v[72:75], v8, s[12:15], s69 offen offset:256 nt
    s_waitcnt vmcnt(3)
    buffer_load_dwordx4 v[76:79], v8, s[12:15], s69 offen offset:512 nt
    s_waitcnt vmcnt(3)
    buffer_load_dwordx4 v[80:83], v8, s[12:15], s69 offen offset:768 nt
    s_waitcnt vmcnt(3)
    buffer_load_dwordx4 v[20:23], v4, s[8:11], s64 offen offset:0 nt
    s_waitcnt vmcnt(3)
    buffer_load_dwordx4 v[24:27], v4, s[8:11], s64 offen offset:1024 nt
    s_waitcnt vmcnt(3)
    buffer_load_dwordx4 v[28:31], v4, s[8:11], s64 offen offset:2048 nt
    s_waitcnt vmcnt(3)
    ds_write_b32 v19, v18 offset:320
    buffer_load_dwordx4 v[32:35], v4, s[8:11], s64 offen offset:3072 nt
    s_waitcnt vmcnt(3)
    buffer_load_dwordx4 v[36:39], v4, s[8:11], s69 offen offset:0 nt
    s_waitcnt vmcnt(3)
    buffer_load_dwordx4 v[40:43], v4, s[8:11], s69 offen offset:1024 nt
    s_waitcnt vmcnt(3)
    ds_write_b32 v19, v18 offset:64
    buffer_load_dwordx4 v[44:47], v4, s[8:11], s69 offen offset:2048 nt
    s_waitcnt vmcnt(3)
    buffer_load_dwordx4 v[48:51], v4, s[8:11], s69 offen offset:3072 nt
    s_branch L_att_se
L_att_sb:
    s_waitcnt lgkmcnt(0)
    s_mov_b32 s8, s28
    s_mov_b32 s9, s29
    s_mov_b32 s10, 0x2000000
    s_mov_b32 s11, 0x00020000
    s_mov_b32 s12, s30
    s_mov_b32 s13, s31
    s_mov_b32 s14, 0x2000000
    s_mov_b32 s15, 0x00020000
    s_mov_b32 s4, s40
    s_mov_b32 s5, s41
    s_mov_b32 s6, 0x400000
    s_mov_b32 s7, 0x00020000
    s_add_u32 s56, s40, 0x2f0000
    s_addc_u32 s57, s41, 0
    s_load_dwordx2 s[74:75], s[56:57], 0
    s_cmp_lg_u32 s71, 0
    s_cbranch_scc1 L_att_b1
    v_lshrrev_b32 v112, 4, v4
    v_and_b32 v113, 15, v112
    v_bfe_u32 v114, v112, 4, 1
    v_lshlrev_b32 v114, 3, v114
    v_lshl_add_u32 v114, v113, 4, v114
    s_mul_i32 s56, s42, 320
    v_add_u32 v114, s56, v114
    v_and_b32 v16, 7, v112
    v_mov_b32 v17, 1.0
    v_cmp_eq_u32 vcc, 0, v16
    s_nop 1
    v_cndmask_b32 v100, v13, v17, vcc
    v_cmp_eq_u32 vcc, 1, v16
    s_nop 1
    v_cndmask_b32 v101, v13, v17, vcc
    v_cmp_eq_u32 vcc, 2, v16
    s_nop 1
    v_cndmask_b32 v102, v13, v17, vcc
    v_cmp_eq_u32 vcc, 3, v16
    s_nop 1
    v_cndmask_b32 v103, v13, v17, vcc
    v_cmp_eq_u32 vcc, 4, v16
    s_nop 1
    v_cndmask_b32 v104, v13, v17, vcc
    v_cmp_eq_u32 vcc, 5, v16
    s_nop 1
    v_cndmask_b32 v105, v13, v17, vcc
    v_cmp_eq_u32 vcc, 6, v16
    s_nop 1
    v_cndmask_b32 v106, v13, v17, vcc
    v_cmp_eq_u32 vcc, 7, v16
    s_nop 1
    v_cndmask_b32 v107, v13, v17, vcc
    s_waitcnt lgkmcnt(0)
    s_add_u32 s74, s74, 1
    s_addc_u32 s75, s75, 0
    s_lshr_b64 s[56:57], s[74:75], 0
    s_and_b32 s57, s56, 0x4000
    s_and_b32 s56, s56, 0x3fff
    s_lshl_b32 s57, s57, 1
    s_or_b32 s60, s56, s57
    s_lshr_b64 s[56:57], s[74:75], 15
    s_and_b32 s57, s56, 0x4000
    s_and_b32 s56, s56, 0x3fff
    s_lshl_b32 s57, s57, 1
    s_or_b32 s61, s56, s57
    s_lshr_b64 s[56:57], s[74:75], 30
    s_and_b32 s57, s56, 0x4000
    s_and_b32 s56, s56, 0x3fff
    s_lshl_b32 s57, s57, 1
    s_or_b32 s62, s56, s57
    s_lshr_b64 s[56:57], s[74:75], 45
    s_and_b32 s57, s56, 0x4000
    s_and_b32 s56, s56, 0x3fff
    s_lshl_b32 s57, s57, 1
    s_or_b32 s63, s56, s57
    s_lshr_b32 s58, s73, 2
    s_lshl_b32 s56, s48, 16
    s_lshl_b32 s57, s58, 14
    s_add_u32 s56, s56, s57
    s_lshl_b32 s57, s42, 12
    s_add_u32 s56, s56, s57
    s_add_u32 s58, s56, 0x200000
    v_mov_b32 v0, 1
    ds_write_b32 v13, v0 offset:248
LW_1:
    ds_read_b32 v16, v14 offset:64
    s_waitcnt lgkmcnt(0)
    v_cmp_gt_u32 vcc, 1, v16
    s_cbranch_vccnz ST_2
    s_setprio 3
LQ_3:
    buffer_load_dwordx4 v[84:87], v4, s[4:7], s58 offen offset:0 sc1
    buffer_load_dwordx4 v[88:91], v4, s[4:7], s58 offen offset:1024 sc1
    buffer_load_dwordx4 v[92:95], v4, s[4:7], s58 offen offset:2048 sc1
    buffer_load_dwordx4 v[96:99], v4, s[4:7], s58 offen offset:3072 sc1
    s_waitcnt vmcnt(0)
    v_bitop3_b32 v120, v84, v88, s60 bitop3:0x7e
    v_bitop3_b32 v124, v92, v96, s60 bitop3:0x7e
    v_bitop3_b32 v121, v85, v89, s61 bitop3:0x7e
    v_bitop3_b32 v125, v93, v97, s61 bitop3:0x7e
    v_bitop3_b32 v122, v86, v90, s62 bitop3:0x7e
    v_bitop3_b32 v126, v94, v98, s62 bitop3:0x7e
    v_bitop3_b32 v123, v87, v91, s63 bitop3:0x7e
    v_bitop3_b32 v127, v95, v99, s63 bitop3:0x7e
    v_or3_b32 v16, v120, v121, v122
    v_or3_b32 v17, v123, v124, v125
    v_or3_b32 v16, v16, v126, v127
    v_or_b32 v16, v16, v17
    v_and_b32 v16, 0xffff, v16
    v_cmp_ne_u32 vcc, 0, v16
    s_and_b64 exec, exec, vcc
    s_cbranch_scc0 LQD_4
    s_sleep 1
    s_sub_u32 s52, s52, 1
    s_cbranch_scc0 LQ_3
    s_branch L_end
LQD_4:
    s_mov_b64 exec, -1
    v_mfma_f32_16x16x32_bf16 v[108:111], v[100:103], v[84:87], 0
    v_mfma_f32_16x16x32_bf16 v[108:111], v[100:103], v[88:91], v[108:111]
    v_mfma_f32_16x16x32_bf16 v[108:111], v[104:107], v[92:95], v[108:111]
    v_mfma_f32_16x16x32_bf16 v[108:111], v[104:107], v[96:99], v[108:111]
    s_nop 7
    v_mul_f32 v108, 0x3e0293ee, v108
    v_mul_f32 v109, 0x3e0293ee, v109
    v_mul_f32 v110, 0x3e0293ee, v110
    v_mul_f32 v111, 0x3e0293ee, v111
    v_cvt_pk_bf16_f32 v108, v108, v109
    v_cvt_pk_bf16_f32 v109, v110, v111
    ds_write_b64 v114, v[108:109] offset:1024
    ds_write_b32 v14, v0 offset:16
    s_setprio 0
    s_branch L_att_b2
L_att_b1:
    s_cmp_lg_u32 s42, 0
    s_cbranch_scc1 L_att_b2
LW_5:
    ds_read_b32 v16, v13 offset:320
    s_waitcnt lgkmcnt(0)
    v_cmp_gt_u32 vcc, 1, v16
    s_cbranch_vccnz ST_6
    s_add_u32 s74, s74, 1
    s_addc_u32 s75, s75, 0
    v_mov_b32 v16, s74
    v_mov_b32 v17, s75
    s_lshl_b32 s56, s48, 12
    s_lshl_b32 s57, s49, 7
    s_add_u32 s56, s56, s57
    s_add_u32 s58, s56, 0x2b0000
    s_mov_b64 exec, 1
    buffer_store_dwordx2 v[16:17], v13, s[4:7], s58 offen
    s_mov_b64 exec, -1
L_att_b2:
LX_7:
    ds_read_b128 v[120:123], v13 offset:16
    s_waitcnt lgkmcnt(0)
    v_min3_u32 v120, v120, v121, v122
    v_min_u32 v120, v120, v123
    v_cmp_gt_u32 vcc, 1, v120
    s_cbranch_vccnz ST_8
    buffer_load_dwordx4 v[52:55], v8, s[12:15], s64 offen offset:0 nt
    buffer_load_dwordx4 v[56:59], v8, s[12:15], s64 offen offset:256 nt
    buffer_load_dwordx4 v[60:63], v8, s[12:15], s64 offen offset:512 nt
    buffer_load_dwordx4 v[64:67], v8, s[12:15], s64 offen offset:768 nt
LX_9:
    ds_read_b128 v[120:123], v13 offset:144
    s_waitcnt lgkmcnt(0)
    v_min3_u32 v120, v120, v121, v122
    v_min_u32 v120, v120, v123
    v_cmp_gt_u32 vcc, 1, v120
    s_cbranch_vccnz ST_10
LX_11:
    ds_read_b128 v[120:123], v13 offset:160
    s_waitcnt lgkmcnt(0)
    v_min3_u32 v120, v120, v121, v122
    v_min_u32 v120, v120, v123
    v_cmp_gt_u32 vcc, 1, v120
    s_cbranch_vccnz ST_12
    buffer_load_dwordx4 v[68:71], v8, s[12:15], s69 offen offset:0 nt
    buffer_load_dwordx4 v[72:75], v8, s[12:15], s69 offen offset:256 nt
    buffer_load_dwordx4 v[76:79], v8, s[12:15], s69 offen offset:512 nt
    buffer_load_dwordx4 v[80:83], v8, s[12:15], s69 offen offset:768 nt
    buffer_load_dwordx4 v[20:23], v4, s[8:11], s64 offen offset:0 nt
    buffer_load_dwordx4 v[24:27], v4, s[8:11], s64 offen offset:1024 nt
    buffer_load_dwordx4 v[28:31], v4, s[8:11], s64 offen offset:2048 nt
    buffer_load_dwordx4 v[32:35], v4, s[8:11], s64 offen offset:3072 nt
    s_waitcnt vmcnt(11)
    buffer_load_dwordx4 v[36:39], v4, s[8:11], s69 offen offset:0 nt
    s_waitcnt vmcnt(11)
    buffer_load_dwordx4 v[40:43], v4, s[8:11], s69 offen offset:1024 nt
    s_waitcnt vmcnt(11)
    buffer_load_dwordx4 v[44:47], v4, s[8:11], s69 offen offset:2048 nt
    s_waitcnt vmcnt(11)
    buffer_load_dwordx4 v[48:51], v4, s[8:11], s69 offen offset:3072 nt
    ds_write_b32 v19, v18 offset:416
L_att_se:
    s_lshl_b32 s58, s43, 4
    v_add_u32 v0, s58, v14
    s_mov_b32 s70, 0
    s_lshl_b32 s56, s48, 15
    s_lshl_b32 s57, s67, 8
    s_add_u32 s56, s56, s57
    s_lshl_b32 s57, s42, 6
    s_add_u32 s56, s56, s57
    s_add_u32 s65, s56, 0x80000
    s_lshr_b32 s60, s67, 3
    s_and_b32 s61, s67, 3
    s_bfe_u32 s62, s67, 0x10002
    s_lshl_b32 s56, s48, 15
    s_lshl_b32 s57, s60, 8
    s_add_u32 s56, s56, s57
    s_lshl_b32 s57, s42, 6
    s_add_u32 s56, s56, s57
    s_lshl_b32 s57, s61, 4
    s_add_u32 s56, s56, s57
    s_lshl_b32 s57, s62, 3
    s_add_u32 s56, s56, s57
    s_add_u32 s66, s56, 0xc0000
    v_lshlrev_b32 v16, 2, v2
    v_lshl_add_u32 v10, v3, 13, v16
    v_and_b32 v16, 3, v1
    v_cmp_eq_u32 vcc, 0, v16
    s_nop 1
    v_cndmask_b32 v12, 0, 1, vcc
    v_lshrrev_b32 v18, 2, v2
    v_lshlrev_b32 v19, 4, v3
    v_lshl_add_u32 v9, v18, 8, v19
    v_lshl_add_u32 v9, v18, 6, v9
    s_lshl_b32 s56, s43, 7
    v_add_u32 v17, s56, v19
    v_lshl_add_u32 v15, v18, 4, v14
    v_add_u32 v15, s56, v15
    s_lshl_b32 s56, s71, 12
    v_add_u32 v16, s56, v4
    s_lshl_b32 s56, s42, 10
    v_add_u32 v5, s56, v16
    v_lshlrev_b32 v19, 10, v18
    v_and_b32 v1, 0x33, v1
    v_cmp_eq_u32 vcc, 0, v1
    v_mov_b32 v1, 0x40000000
    s_nop 0
    v_cndmask_b32 v11, v1, v19, vcc
    s_lshl_b32 s56, s71, 15
    s_lshl_b32 s57, s42, 13
    s_add_u32 s56, s56, s57
    s_add_u32 s60, s56, 0x4000
    s_lshl_b32 s56, s71, 15
    s_lshl_b32 s57, s42, 11
    s_add_u32 s56, s56, s57
    s_add_u32 s61, s56, 0x4000
    v_xor_b32 v19, v2, v3
    v_lshlrev_b32 v19, 4, v19
    v_add_u32 v19, s60, v19
    v_add_u32 v19, 0x10000, v19
    v_lshl_add_u32 v6, v3, 8, v19
    v_lshl_add_u32 v7, v2, 8, v19
    v_mov_b32 v2, s58
    v_mov_b32 v3, v0
    s_waitcnt vmcnt(8)
    v_perm_b32 v84, v56, v52, s53
    v_perm_b32 v85, v64, v60, s53
    v_perm_b32 v86, v72, v68, s53
    v_perm_b32 v87, v80, v76, s53
    v_perm_b32 v88, v56, v52, s54
    v_perm_b32 v89, v64, v60, s54
    v_perm_b32 v90, v72, v68, s54
    v_perm_b32 v91, v80, v76, s54
    v_perm_b32 v92, v57, v53, s53
    v_perm_b32 v93, v65, v61, s53
    v_perm_b32 v94, v73, v69, s53
    v_perm_b32 v95, v81, v77, s53
    v_perm_b32 v96, v57, v53, s54
    v_perm_b32 v97, v65, v61, s54
    v_perm_b32 v98, v73, v69, s54
    v_perm_b32 v99, v81, v77, s54
    v_perm_b32 v100, v58, v54, s53
    v_perm_b32 v101, v66, v62, s53
    v_perm_b32 v102, v74, v70, s53
    v_perm_b32 v103, v82, v78, s53
    v_perm_b32 v104, v58, v54, s54
    v_perm_b32 v105, v66, v62, s54
    v_perm_b32 v106, v74, v70, s54
    v_perm_b32 v107, v82, v78, s54
    v_perm_b32 v108, v59, v55, s53
    v_perm_b32 v109, v67, v63, s53
    v_perm_b32 v110, v75, v71, s53
    v_perm_b32 v111, v83, v79, s53
    v_perm_b32 v112, v59, v55, s54
    v_perm_b32 v113, v67, v63, s54
    v_perm_b32 v114, v75, v71, s54
    v_perm_b32 v115, v83, v79, s54
    v_add_u32 v1, s60, v4
    ds_write_b128 v1, v[84:87] offset:0
    ds_write_b128 v1, v[88:91] offset:1024
    ds_write_b128 v1, v[92:95] offset:2048
    ds_write_b128 v1, v[96:99] offset:3072
    ds_write_b128 v1, v[100:103] offset:4096
    ds_write_b128 v1, v[104:107] offset:5120
    ds_write_b128 v1, v[108:111] offset:6144
    ds_write_b128 v1, v[112:115] offset:7168
    v_mov_b32 v0, 1
    ds_write_b32 v3, v0 offset:256
    v_add_u32 v1, s61, v4
LX_13:
    ds_read_b128 v[120:123], v2 offset:256
    s_waitcnt lgkmcnt(0)
    v_min3_u32 v120, v120, v121, v122
    v_min_u32 v120, v120, v123
    v_cmp_gt_u32 vcc, 1, v120
    s_cbranch_vccnz ST_14
    ds_read_b128 v[52:55], v1 offset:0
    ds_read_b128 v[56:59], v1 offset:1024
    ds_read_b128 v[60:63], v1 offset:8192
    ds_read_b128 v[64:67], v1 offset:9216
    ds_read_b128 v[68:71], v1 offset:16384
    ds_read_b128 v[72:75], v1 offset:17408
    ds_read_b128 v[76:79], v1 offset:24576
    ds_read_b128 v[80:83], v1 offset:25600
    s_waitcnt lgkmcnt(0)
    s_waitcnt vmcnt(4)
    v_xor_b32 v1, 0, v6
    ds_write_b128 v1, v[20:23] offset:0
    v_xor_b32 v1, 64, v6
    ds_write_b128 v1, v[24:27] offset:1024
    v_xor_b32 v1, 128, v6
    ds_write_b128 v1, v[28:31] offset:2048
    v_xor_b32 v1, 192, v6
    ds_write_b128 v1, v[32:35] offset:3072
    v_xor_b32 v1, 0, v7
    ds_read_b128 v[20:23], v1 offset:0
    v_xor_b32 v1, 64, v7
    ds_read_b128 v[24:27], v1 offset:0
    v_xor_b32 v1, 128, v7
    ds_read_b128 v[28:31], v1 offset:0
    v_xor_b32 v1, 192, v7
    ds_read_b128 v[32:35], v1 offset:0
    s_waitcnt vmcnt(0)
    v_xor_b32 v1, 0, v6
    ds_write_b128 v1, v[36:39] offset:4096
    v_xor_b32 v1, 64, v6
    ds_write_b128 v1, v[40:43] offset:5120
    v_xor_b32 v1, 128, v6
    ds_write_b128 v1, v[44:47] offset:6144
    v_xor_b32 v1, 192, v6
    ds_write_b128 v1, v[48:51] offset:7168
    v_xor_b32 v1, 0, v7
    ds_read_b128 v[36:39], v1 offset:4096
    v_xor_b32 v1, 64, v7
    ds_read_b128 v[40:43], v1 offset:4096
    v_xor_b32 v1, 128, v7
    ds_read_b128 v[44:47], v1 offset:4096
    v_xor_b32 v1, 192, v7
    ds_read_b128 v[48:51], v1 offset:4096
LW_15:
    ds_read_b32 v1, v13 offset:240
    s_waitcnt lgkmcnt(0)
    v_cmp_gt_u32 vcc, 1, v1
    s_cbranch_vccnz ST_16
    v_readfirstlane_b32 s55, v1
    s_lshr_b32 s55, s55, 1
L_att_loop:
    s_setprio 0
    v_mov_b32 v0, s50
LW_17:
    ds_read_b32 v1, v13 offset:248
    s_waitcnt lgkmcnt(0)
    v_cmp_gt_u32 vcc, s50, v1
    s_cbranch_vccnz ST_18
    s_setprio 1
LX_19:
    ds_read_b128 v[120:123], v13 offset:16
    s_waitcnt lgkmcnt(0)
    v_min3_u32 v120, v120, v121, v122
    v_min_u32 v120, v120, v123
    v_cmp_gt_u32 vcc, s50, v120
    s_cbranch_vccnz ST_20
    ds_read_b128 v[100:103], v9 offset:1024
    ds_read_b128 v[104:107], v9 offset:1088
    ds_read_b128 v[108:111], v9 offset:1152
    ds_read_b128 v[112:115], v9 offset:1216
    s_setprio 3
    s_waitcnt lgkmcnt(3)
    v_mfma_f32_16x16x32_bf16 v[120:123], v[20:23], v[100:103], 0
    s_waitcnt lgkmcnt(2)
    v_mfma_f32_16x16x32_bf16 v[120:123], v[24:27], v[104:107], v[120:123]
    s_waitcnt lgkmcnt(1)
    v_mfma_f32_16x16x32_bf16 v[120:123], v[28:31], v[108:111], v[120:123]
    s_waitcnt lgkmcnt(0)
    v_mfma_f32_16x16x32_bf16 v[120:123], v[32:35], v[112:115], v[120:123]
    v_mfma_f32_16x16x32_bf16 v[124:127], v[36:39], v[100:103], 0
    v_mfma_f32_16x16x32_bf16 v[124:127], v[40:43], v[104:107], v[124:127]
    v_mfma_f32_16x16x32_bf16 v[124:127], v[44:47], v[108:111], v[124:127]
    v_mfma_f32_16x16x32_bf16 v[124:127], v[48:51], v[112:115], v[124:127]
    s_nop 3
    v_max3_f32 v18, v120, v121, v122
    v_max_f32 v18, v18, v123
    s_nop 1
    v_max3_f32 v18, v18, v124, v125
    v_max3_f32 v18, v18, v126, v127
    v_mov_b32 v1, v18
    s_nop 1
    v_permlane32_swap_b32 v18, v1
    v_max_f32 v18, v18, v1
    v_mov_b32 v1, v18
    s_nop 1
    v_permlane16_swap_b32 v18, v1
    v_max_f32 v18, v18, v1
    v_pk_add_f32 v[120:121], v[120:121], v[18:19] op_sel_hi:[1,0] neg_lo:[0,1] neg_hi:[0,1]
    v_pk_add_f32 v[122:123], v[122:123], v[18:19] op_sel_hi:[1,0] neg_lo:[0,1] neg_hi:[0,1]
    v_pk_add_f32 v[124:125], v[124:125], v[18:19] op_sel_hi:[1,0] neg_lo:[0,1] neg_hi:[0,1]
    v_pk_add_f32 v[126:127], v[126:127], v[18:19] op_sel_hi:[1,0] neg_lo:[0,1] neg_hi:[0,1]
    ds_write_b32 v15, v18 offset:512
    v_exp_f32 v120, v120
    v_exp_f32 v121, v121
    v_exp_f32 v122, v122
    v_exp_f32 v123, v123
    v_exp_f32 v124, v124
    v_exp_f32 v125, v125
    v_exp_f32 v126, v126
    v_exp_f32 v127, v127
    v_cvt_pk_bf16_f32 v116, v120, v121
    v_cvt_pk_bf16_f32 v117, v122, v123
    v_cvt_pk_bf16_f32 v118, v124, v125
    v_cvt_pk_bf16_f32 v119, v126, v127
    ds_write_b128 v5, v[116:119] offset:4096
    ds_write_b32 v3, v0 offset:176
    v_pk_add_f32 v[124:125], v[124:125], v[120:121]
    v_pk_add_f32 v[126:127], v[126:127], v[122:123]
    ds_read_b128 v[84:87], v2 offset:176
    ds_read_b128 v[120:123], v17 offset:512
    ds_read_b128 v[116:119], v16 offset:4096
    ds_read_b128 v[104:107], v16 offset:5120
    ds_read_b128 v[108:111], v16 offset:6144
    ds_read_b128 v[112:115], v16 offset:7168
    s_cmp_eq_u32 s55, 0
    v_pk_add_f32 v[124:125], v[124:125], v[126:127]
    v_add_f32 v19, v124, v125
    v_add_f32 v1, v124, v125
    s_nop 1
    v_permlane32_swap_b32 v19, v1
    v_add_f32 v124, v19, v1
    v_add_f32 v19, v19, v1
    s_nop 1
    v_permlane16_swap_b32 v19, v124
    v_add_f32 v19, v19, v124
    v_bfi_b32 v19, 1, s51, v19
    s_cbranch_scc1 ST_24
    buffer_store_dwordx2 v[18:19], v11, s[4:7], s66 offen
LSD_23:
    s_waitcnt lgkmcnt(5)
    v_min3_u32 v84, v84, v85, v86
    v_min_u32 v84, v84, v87
    v_cmp_gt_u32 vcc, s50, v84
    s_cbranch_vccnz LXS_22
LXD_21:
    s_waitcnt lgkmcnt(0)
    v_mfma_f32_16x16x32_bf16 v[84:87], v[116:119], v[52:55], 0
    v_max3_f32 v124, v120, v121, v122
    v_max_f32 v124, v124, v123
    v_mfma_f32_16x16x32_bf16 v[86:89], v[116:119], v[56:59], 0
    v_pk_add_f32 v[120:121], v[120:121], v[124:125] op_sel_hi:[1,0] neg_lo:[0,1] neg_hi:[0,1]
    v_pk_add_f32 v[122:123], v[122:123], v[124:125] op_sel_hi:[1,0] neg_lo:[0,1] neg_hi:[0,1]
    v_mfma_f32_16x16x32_bf16 v[88:91], v[104:107], v[60:63], 0
    v_exp_f32 v120, v120
    v_exp_f32 v121, v121
    v_mfma_f32_16x16x32_bf16 v[90:93], v[104:107], v[64:67], 0
    v_exp_f32 v122, v122
    v_exp_f32 v123, v123
    v_mfma_f32_16x16x32_bf16 v[92:95], v[108:111], v[68:71], 0
    v_mfma_f32_16x16x32_bf16 v[94:97], v[108:111], v[72:75], 0
    v_mfma_f32_16x16x32_bf16 v[96:99], v[112:115], v[76:79], 0
    v_mfma_f32_16x16x32_bf16 v[98:101], v[112:115], v[80:83], 0
    s_cmp_eq_u32 s55, 0
    v_mul_f32 v126, v120, v84
    v_mul_f32 v127, v120, v86
    v_fmac_f32 v126, v121, v88
    v_fmac_f32 v127, v121, v90
    v_fmac_f32 v126, v122, v92
    v_fmac_f32 v127, v122, v94
    v_fmac_f32 v126, v123, v96
    v_fmac_f32 v127, v123, v98
    v_cvt_pk_bf16_f32 v126, v126, v127
    v_bfi_b32 v126, v12, s51, v126
    s_cbranch_scc1 ST_26
    buffer_store_dword v126, v10, s[4:7], s65 offen
LSD_25:
    v_and_b32 v1, 31, v3
    ds_write_b32 v1, v0 offset:144
    s_brev_b32 s70, 1
    s_cmp_eq_u32 s50, 4
    s_cbranch_scc1 L_att_fin
    s_add_u32 s50, s50, 1
    s_cmp_lg_u32 s71, 0
    s_cbranch_scc1 L_att_nc
    s_setprio 0
    v_mov_b32 v0, s50
    v_lshrrev_b32 v104, 4, v4
    v_and_b32 v105, 15, v104
    v_bfe_u32 v106, v104, 4, 1
    v_lshlrev_b32 v106, 3, v106
    v_lshl_add_u32 v106, v105, 4, v106
    s_mul_i32 s56, s42, 320
    v_add_u32 v106, s56, v106
    v_mov_b32 v1, v104
    v_and_b32 v120, 1, v1
    v_lshlrev_b32 v120, 4, v120
    v_mov_b32 v121, 0x3f80
    v_lshlrev_b32 v120, v120, v121
    v_bfe_u32 v121, v1, 1, 2
    v_cmp_eq_u32 vcc, 0, v121
    s_nop 1
    v_cndmask_b32 v92, v13, v120, vcc
    v_cmp_eq_u32 vcc, 1, v121
    s_nop 1
    v_cndmask_b32 v93, v13, v120, vcc
    v_cmp_eq_u32 vcc, 2, v121
    s_nop 1
    v_cndmask_b32 v94, v13, v120, vcc
    v_cmp_eq_u32 vcc, 3, v121
    s_nop 1
    v_cndmask_b32 v95, v13, v120, vcc
    v_and_b32 v110, 7, v1
    v_lshlrev_b32 v110, 7, v110
    s_xor_b32 s63, s51, 1
    s_lshr_b32 s58, s73, 2
    s_lshl_b32 s56, s48, 15
    s_lshl_b32 s57, s58, 13
    s_add_u32 s56, s56, s57
    s_lshl_b32 s57, s42, 11
    s_add_u32 s56, s56, s57
    s_add_u32 s60, s56, 0x0
    s_lshr_b32 s62, s42, 1
    s_lshl_b32 s56, s48, 15
    s_lshl_b32 s57, s62, 12
    s_add_u32 s56, s56, s57
    s_lshl_b32 s57, s58, 10
    s_add_u32 s56, s56, s57
    s_add_u32 s61, s56, 0xc6000
    s_lshl_b32 s56, s48, 15
    s_lshl_b32 s57, s63, 13
    s_add_u32 s56, s56, s57
    s_lshl_b32 s57, s42, 11
    s_add_u32 s56, s56, s57
    s_add_u32 s58, s56, 0xc2000
    s_mov_b32 s63, 0
    s_cmp_gt_u32 s50, 2
    s_cbranch_scc1 LZ_27
    s_sleep 36
LZ_27:
LP_28:
    buffer_load_dwordx4 v[84:87], v4, s[4:7], s58 offen offset:0 sc1
    buffer_load_dwordx4 v[88:91], v4, s[4:7], s58 offen offset:1024 sc1
    s_waitcnt vmcnt(0)
    v_bitop3_b32 v1, v84, v88, 0 bitop3:0x7e
    v_and_b32 v1, 1, v1
    v_cmp_ne_u32 vcc, 0, v1
    s_cbranch_vccnz ST_29
    s_mov_b64 exec, -1
LX_30:
    ds_read_b128 v[120:123], v13 offset:416
    s_waitcnt lgkmcnt(0)
    v_min3_u32 v120, v120, v121, v122
    v_min_u32 v120, v120, v123
    v_cmp_gt_u32 vcc, 1, v120
    s_cbranch_vccnz ST_31
LX_32:
    ds_read_b128 v[120:123], v13 offset:432
    s_waitcnt lgkmcnt(0)
    v_min3_u32 v120, v120, v121, v122
    v_min_u32 v120, v120, v123
    v_cmp_gt_u32 vcc, 1, v120
    s_cbranch_vccnz ST_33
    v_mfma_f32_16x16x32_bf16 v[100:103], v[92:95], v[84:87], 0
    v_mfma_f32_16x16x32_bf16 v[100:103], v[92:95], v[88:91], v[100:103]
    s_cmp_gt_u32 s50, 2
    s_cbranch_scc1 LP_34
    buffer_load_dwordx4 v[84:87], v4, s[4:7], s60 offen offset:0 sc1
    buffer_load_dwordx4 v[88:91], v4, s[4:7], s60 offen offset:1024 sc1
LP_34:
    buffer_load_dwordx4 v[108:111], v4, s[4:7], s61 offen sc1
    s_waitcnt vmcnt(0)
    v_bitop3_b32 v1, v109, v111, s50 bitop3:0x7e
    v_and_b32 v1, 1, v1
    v_cmp_ne_u32 vcc, 0, v1
    s_cbranch_vccnz ST_36
    s_mov_b64 exec, -1
    buffer_load_dwordx4 v[84:87], v4, s[4:7], s60 offen offset:0 sc1
    buffer_load_dwordx4 v[88:91], v4, s[4:7], s60 offen offset:1024 sc1
    s_setprio 3
    ds_write_b32 v13, v0 offset:248
    v_pk_add_f32 v[108:109], v[108:109], v[110:111]
    s_nop 1
    v_add_f32_dpp v108, v108, v108 row_ror:8 row_mask:0xf bank_mask:0xf
    v_add_f32_dpp v109, v109, v109 row_ror:8 row_mask:0xf bank_mask:0xf
    s_nop 0
    v_add_f32_dpp v108, v108, v108 row_ror:4 row_mask:0xf bank_mask:0xf
    v_add_f32_dpp v109, v109, v109 row_ror:4 row_mask:0xf bank_mask:0xf
    s_nop 0
    v_add_f32_dpp v108, v108, v108 row_ror:2 row_mask:0xf bank_mask:0xf
    v_add_f32_dpp v109, v109, v109 row_ror:2 row_mask:0xf bank_mask:0xf
    s_nop 0
    v_add_f32_dpp v108, v108, v108 row_ror:1 row_mask:0xf bank_mask:0xf
    v_add_f32_dpp v109, v109, v109 row_ror:1 row_mask:0xf bank_mask:0xf
    v_mov_b32 v112, v108
    v_mov_b32 v113, v109
    s_nop 0
    v_permlane32_swap_b32 v108, v112
    v_permlane32_swap_b32 v109, v113
    v_pk_add_f32 v[108:109], v[108:109], v[112:113]
    v_mov_b32 v112, v108
    v_mov_b32 v113, v109
    s_nop 0
    v_permlane16_swap_b32 v108, v112
    v_permlane16_swap_b32 v109, v113
    v_pk_add_f32 v[108:109], v[108:109], v[112:113]
    v_mul_f32 v108, 0xbb000000, v108
    v_mul_f32 v109, 0x3b000000, v109
    v_pk_mul_f32 v[100:101], v[100:101], v[108:109] op_sel_hi:[1,0]
    v_pk_mul_f32 v[102:103], v[102:103], v[108:109] op_sel_hi:[1,0]
    v_fma_f32 v109, -v108, v108, v109
    v_max_f32 v109, 0, v109
    v_add_f32 v109, 0x3727c5ac, v109
    v_rsq_f32 v109, v109
    s_nop 0
    v_mul_f32 v109, 0x3e0293ee, v109
LO_37:
    s_waitcnt vmcnt(1)
    v_mfma_f32_16x16x32_bf16 v[96:99], v[92:95], v[84:87], v[100:103]
    s_waitcnt vmcnt(0)
    v_mfma_f32_16x16x32_bf16 v[96:99], v[92:95], v[88:91], v[96:99]
    v_bitop3_b32 v1, v84, v88, s50 bitop3:0x7e
    v_and_b32 v1, 1, v1
    v_cmp_ne_u32 vcc, 0, v1
    s_cbranch_vccnz ST_38
    s_nop 3
    v_pk_mul_f32 v[96:97], v[96:97], v[108:109] op_sel:[0,1] op_sel_hi:[1,1]
    v_pk_mul_f32 v[98:99], v[98:99], v[108:109] op_sel:[0,1] op_sel_hi:[1,1]
    v_cvt_pk_bf16_f32 v96, v96, v97
    v_cvt_pk_bf16_f32 v97, v98, v99
    ds_write_b64 v106, v[96:97] offset:1024
    ds_write_b32 v14, v0 offset:16
L_att_nc:
    s_add_u32 s50, s50, 1
    s_cmp_le_u32 s50, 4
    s_cbranch_scc1 L_att_loop
    s_branch L_end
L_att_fin:
    s_cmp_lg_u32 s2, 8
    s_cbranch_scc1 L_end
    s_or_b32 s56, s42, s71
    s_cmp_lg_u32 s56, 0
    s_cbranch_scc1 L_end
    v_mov_b32 v18, s74
    v_mov_b32 v19, s75
    s_mov_b64 exec, 1
    s_mov_b32 s58, 0x2f0000
    buffer_store_dwordx2 v[18:19], v13, s[4:7], s58 offen sc1
    s_branch L_end
L_HS:
    s_add_u32 s56, s40, 0x2f0000
    s_addc_u32 s57, s41, 0
    s_load_dwordx2 s[74:75], s[56:57], 0
    v_mov_b32 v16, -1
    v_mov_b32 v17, -1
    v_mov_b32 v18, -1
    v_mov_b32 v19, -1
    s_lshl_b32 s57, s48, 5
    s_add_u32 s67, s57, s49
    s_lshl_b32 s67, s67, 10
    v_lshrrev_b32 v20, 3, v1
    v_lshlrev_b32 v20, 12, v20
    v_and_b32 v21, 7, v1
    v_lshl_add_u32 v20, v21, 4, v20
    s_and_b32 s59, s73, 3
    s_lshr_b32 s60, s73, 2
    s_lshl_b32 s56, s59, 15
    s_lshl_b32 s57, s48, 9
    s_add_u32 s56, s56, s57
    s_lshl_b32 s57, s60, 7
    s_add_u32 s56, s56, s57
    s_lshl_b32 s57, s3, 18
    s_add_u32 s56, s56, s57
    s_add_u32 s66, s56, 0x140000
    s_add_u32 s59, s67, 0x80000
    buffer_store_dwordx4 v[16:19], v4, s[4:7], s59 offen
    s_add_u32 s59, s67, 0xc0000
    buffer_store_dwordx4 v[16:19], v4, s[4:7], s59 offen
    buffer_store_dwordx4 v[16:19], v4, s[4:7], s67 offen
    buffer_store_dwordx4 v[16:19], v20, s[4:7], s66 offen sc1
    s_add_u32 s66, s66, 0x20000
    buffer_store_dwordx4 v[16:19], v20, s[4:7], s66 offen sc1
    s_getreg_b32 s72, hwreg(HW_REG_XCC_ID)
    s_and_b32 s72, s72, 15
    v_mov_b32 v70, s72
    v_mov_b32 v71, 0
    s_lshr_b32 s71, s67, 3
    s_lshl_b32 s58, s48, 5
    v_and_b32 v24, 31, v1
    v_add_u32 v26, s58, v24
    v_lshlrev_b32 v26, 7, v26
    v_add_u32 v24, 0x2c0000, v26
    v_add_u32 v27, 0x2e0000, v26
    v_cmp_gt_u32 vcc, 32, v1
    s_nop 1
    v_cndmask_b32 v24, v27, v24, vcc
    s_waitcnt lgkmcnt(0)
    s_add_u32 s56, s74, 1
    s_addc_u32 s57, s75, 0
    v_mov_b32 v68, s56
    v_mov_b32 v69, s57
    s_waitcnt vmcnt(2)
    s_mov_b64 exec, 1
    s_add_u32 s58, s71, 0x2c0000
    buffer_store_dwordx4 v[68:71], v13, s[4:7], s58 offen
    s_waitcnt vmcnt(1)
    s_add_u32 s58, s71, 0x2e0000
    buffer_store_dwordx4 v[68:71], v13, s[4:7], s58 offen sc1
    s_mov_b64 exec, -1
    v_mov_b32 v29, 0
    v_xor_b32 v28, -1, v68
L_pc_fp:
    s_and_b32 s56, s52, 7
    s_cmp_eq_u32 s56, 1
    s_cselect_b32 exec_hi, -1, 0
    buffer_load_dwordx4 v[28:31], v24, s[4:7], 0 offen sc1
    s_mov_b64 exec, -1
    s_waitcnt vmcnt(0)
    v_xor_b32 v20, v28, v68
    v_bitop3_b32 v20, v20, v29, v69 bitop3:0xf6
    v_cmp_eq_u32 vcc, 0, v20
    v_cmp_eq_u32 s[56:57], s72, v30
    s_and_b32 s58, vcc_lo, s56
    s_cmp_eq_u32 s58, -1
    s_cselect_b32 s58, 3, 0
    s_cmp_lg_u32 s58, 0
    s_cbranch_scc1 L_pc_go
    s_andn2_b32 s58, vcc_hi, s57
    s_cbranch_scc1 L_pc_safe
    s_sleep 1
    s_sub_u32 s52, s52, 1
    s_cbranch_scc0 L_pc_fp
    s_branch L_end
L_pc_safe:
    s_add_u32 s58, s67, 0x80000
    buffer_store_dwordx4 v[16:19], v4, s[4:7], s58 offen sc1
    s_add_u32 s58, s67, 0xc0000
    buffer_store_dwordx4 v[16:19], v4, s[4:7], s58 offen sc1
    s_add_u32 s58, s67, 0x0
    buffer_store_dwordx4 v[16:19], v4, s[4:7], s58 offen sc1
    s_waitcnt vmcnt(0)
    s_mov_b64 exec, 1
    s_add_u32 s58, s71, 0x2d0000
    buffer_store_dwordx4 v[68:71], v13, s[4:7], s58 offen sc1
    s_mov_b64 exec, -1
    v_add_u32 v24, 0x2d0000, v26
L_pc_fp2:
    buffer_load_dwordx4 v[28:31], v24, s[4:7], 0 offen sc1
    s_waitcnt vmcnt(0)
    v_xor_b32 v20, v28, v68
    v_bitop3_b32 v20, v20, v29, v69 bitop3:0xf6
    v_cmp_eq_u32 vcc, 0, v20
    s_mov_b32 s58, 1
    s_cmp_eq_u32 vcc_lo, -1
    s_cbranch_scc1 L_pc_go
    s_sleep 1
    s_sub_u32 s52, s52, 1
    s_cbranch_scc0 L_pc_fp2
    s_branch L_end
L_pc_go:
    v_mov_b32 v20, s58
    ds_write_b32 v13, v20 offset:240
    s_cmp_lg_u32 s3, 0
    s_cbranch_scc1 L_roles
    s_and_b32 s58, s73, 6
    v_and_b32 v24, 31, v1
    v_lshl_add_u32 v25, v24, 3, s58
    v_lshrrev_b32 v27, 5, v1
    v_add_u32 v25, v25, v27
    v_lshlrev_b32 v25, 7, v25
    v_add_u32 v25, 0x2e0000, v25
    s_add_u32 s58, s71, 0x2e0080
L_hs_fp3:
    buffer_load_dwordx2 v[28:29], v25, s[4:7], 0 offen sc1
    buffer_load_dwordx2 v[30:31], v13, s[4:7], s58 offen sc1
    s_waitcnt vmcnt(0)
    v_bitop3_b32 v20, v28, v30, v68 bitop3:0x7e
    v_bitop3_b32 v21, v29, v31, v69 bitop3:0x7e
    v_or_b32 v20, v20, v21
    v_cmp_ne_u32 vcc, 0, v20
    s_cbranch_vccz L_hs_fd
    s_sleep 4
    s_sub_u32 s52, s52, 1
    s_cbranch_scc0 L_hs_fp3
    s_branch L_end
L_hs_fd:
    v_mov_b32 v20, 1
    ds_write_b32 v13, v20 offset:244
    s_branch L_roles
L_PQ:
    s_and_b32 s64, s73, 7
    s_lshr_b32 s65, s73, 3
    s_lshr_b32 s58, s64, 1
    s_and_b32 s59, s64, 1
    s_lshl_b32 s56, s58, 20
    s_lshl_b32 s57, s59, 15
    s_add_u32 s56, s56, s57
    s_lshl_b32 s57, s48, 10
    s_add_u32 s56, s56, s57
    s_lshl_b32 s57, s65, 9
    s_add_u32 s56, s56, s57
    s_lshl_b32 s57, s42, 7
    s_add_u32 s56, s56, s57
    s_add_u32 s66, s56, 0x0
    s_lshl_b32 s56, s58, 8
    s_lshl_b32 s57, s59, 3
    s_add_u32 s56, s56, s57
    s_lshl_b32 s57, s42, 1
    s_add_u32 s56, s56, s57
    s_add_u32 s72, s56, 0x0
    v_lshlrev_b32 v20, 3, v2
    v_and_b32 v22, 1, v3
    v_lshl_add_u32 v21, v22, 19, v20
    v_lshrrev_b32 v23, 1, v3
    v_lshl_add_u32 v6, v23, 13, v21
    s_waitcnt lgkmcnt(0)
    s_barrier
    s_cmp_lg_u32 s43, 0
    s_cselect_b32 s8, s32, s22
    s_cselect_b32 s9, s33, s23
    s_mov_b32 s10, 0x400000
    s_mov_b32 s11, 0x00020000
    s_mov_b32 s44, s16
    s_mov_b32 s45, s17
    s_mov_b32 s46, 0x1000
    s_mov_b32 s47, 0x00020000
    s_cbranch_scc0 L_pq_n0
    s_setprio 3
    s_lshl_b32 s58, s42, 10
    buffer_load_dwordx4 v[96:99], v4, s[44:47], s58 offen
L_pq_n0:
    s_mov_b32 s4, s40
    s_mov_b32 s5, s41
    s_mov_b32 s6, 0x400000
    s_mov_b32 s7, 0x00020000
    s_cmp_lg_u32 s43, 0
    s_cbranch_scc1 L_pq_nw
    s_mov_b32 s59, s66
    buffer_load_dwordx2 v[52:53], v6, s[8:11], s59 offen nt
    s_add_u32 s59, s59, 16384
    buffer_load_dwordx2 v[68:69], v6, s[8:11], s59 offen nt
    s_add_u32 s59, s59, 49152
    buffer_load_dwordx2 v[54:55], v6, s[8:11], s59 offen nt
    s_add_u32 s59, s59, 16384
    buffer_load_dwordx2 v[70:71], v6, s[8:11], s59 offen nt
    s_add_u32 s59, s59, 49152
    buffer_load_dwordx2 v[56:57], v6, s[8:11], s59 offen nt
    s_add_u32 s59, s59, 16384
    buffer_load_dwordx2 v[72:73], v6, s[8:11], s59 offen nt
    s_add_u32 s59, s59, 49152
    buffer_load_dwordx2 v[58:59], v6, s[8:11], s59 offen nt
    s_add_u32 s59, s59, 16384
    buffer_load_dwordx2 v[74:75], v6, s[8:11], s59 offen nt
    s_add_u32 s59, s59, 49152
    buffer_load_dwordx2 v[60:61], v6, s[8:11], s59 offen nt
    s_add_u32 s59, s59, 16384
    buffer_load_dwordx2 v[76:77], v6, s[8:11], s59 offen nt
    s_add_u32 s59, s59, 49152
    buffer_load_dwordx2 v[62:63], v6, s[8:11], s59 offen nt
    s_add_u32 s59, s59, 16384
    buffer_load_dwordx2 v[78:79], v6, s[8:11], s59 offen nt
    s_add_u32 s59, s59, 49152
    buffer_load_dwordx2 v[64:65], v6, s[8:11], s59 offen nt
    s_add_u32 s59, s59, 16384
    buffer_load_dwordx2 v[80:81], v6, s[8:11], s59 offen nt
    s_add_u32 s59, s59, 49152
    buffer_load_dwordx2 v[66:67], v6, s[8:11], s59 offen nt
    s_add_u32 s59, s59, 16384
    buffer_load_dwordx2 v[82:83], v6, s[8:11], s59 offen nt
L_pq_nw:
    s_add_u32 s56, s40, 0x2f0000
    s_addc_u32 s57, s41, 0
    s_load_dwordx2 s[74:75], s[56:57], 0
    v_bfe_u32 v21, v2, 1, 2
    v_and_b32 v23, 1, v2
    v_lshlrev_b32 v23, 1, v23
    v_add_u32 v23, v23, v22
    v_lshlrev_b32 v24, 10, v21
    v_lshl_add_u32 v11, v23, 6, v24
    s_cmp_eq_u32 s43, 0
    s_cbranch_scc1 L_pq_nx
    buffer_load_ushort v116, v11, s[44:47], s72 offen offset:0
    buffer_load_ushort v117, v11, s[44:47], s72 offen offset:16
    buffer_load_ushort v118, v11, s[44:47], s72 offen offset:32
    buffer_load_ushort v119, v11, s[44:47], s72 offen offset:48
L_pq_nx:
    v_lshlrev_b32 v5, 3, v21
    v_lshlrev_b32 v24, 7, v21
    v_lshl_add_u32 v24, v23, 3, v24
    s_lshl_b32 s58, s42, 5
    v_add_u32 v9, s58, v24
    s_lshl_b32 s58, s42, 10
    v_add_u32 v17, s58, v4
    v_mov_b32 v25, 0x40000000
    v_lshl_add_u32 v7, v3, 13, v20
    v_cmp_gt_u32 vcc, 16, v1
    s_nop 1
    v_cndmask_b32 v12, v25, v20, vcc
    v_and_b32 v24, 1, v2
    v_xor_b32 v15, 1, v24
    v_lshlrev_b32 v24, 11, v24
    v_lshl_add_u32 v24, v3, 14, v24
    v_lshrrev_b32 v26, 1, v2
    v_lshl_add_u32 v16, v26, 4, v24
    v_lshlrev_b32 v24, 3, v3
    v_lshlrev_b32 v26, 2, v3
    v_add_u32 v27, 4, v24
    v_cmp_eq_u32 vcc, v26, v2
    s_nop 1
    v_cndmask_b32 v8, v25, v27, vcc
    v_cmp_eq_u32 vcc, 1, v2
    s_nop 1
    v_cndmask_b32 v8, v8, v24, vcc
    s_or_b32 s63, s42, s65
    s_cmp_eq_u32 s63, 0
    s_cselect_b32 s63, 0, 0x40000000
    v_or_b32 v8, s63, v8
    v_lshlrev_b32 v24, 10, v21
    v_lshl_add_u32 v24, v23, 3, v24
    v_and_b32 v26, 0x28, v1
    v_cmp_eq_u32 s[56:57], 0, v26
    s_nop 1
    v_cndmask_b32 v8, v25, v24, s[56:57]
    v_lshrrev_b32 v24, 2, v2
    v_lshlrev_b32 v24, 7, v24
    v_lshl_add_u32 v10, v3, 4, v24
    v_and_b32 v24, 1, v1
    v_lshlrev_b32 v24, 4, v24
    v_mov_b32 v26, 0x3f80
    v_lshlrev_b32 v24, v24, v26
    v_bfe_u32 v26, v1, 1, 2
    v_cmp_eq_u32 vcc, 0, v26
    s_nop 1
    v_cndmask_b32 v120, v13, v24, vcc
    v_cmp_eq_u32 vcc, 1, v26
    s_nop 1
    v_cndmask_b32 v121, v13, v24, vcc
    v_cmp_eq_u32 vcc, 2, v26
    s_nop 1
    v_cndmask_b32 v122, v13, v24, vcc
    v_cmp_eq_u32 vcc, 3, v26
    s_nop 1
    v_cndmask_b32 v123, v13, v24, vcc
    v_mov_b32 v0, 1
    s_lshr_b32 s58, s42, 1
    s_and_b32 s59, s42, 1
    s_lshl_b32 s56, s48, 15
    s_lshl_b32 s57, s65, 12
    s_add_u32 s56, s56, s57
    s_lshl_b32 s57, s58, 11
    s_add_u32 s56, s56, s57
    s_lshl_b32 s57, s64, 8
    s_add_u32 s56, s56, s57
    s_lshl_b32 s57, s59, 7
    s_add_u32 s56, s56, s57
    s_add_u32 s71, s56, 0x0
    s_mov_b32 s56, s71
    s_add_u32 s67, s56, 0x0
    s_mov_b32 s56, s71
    s_lshl_b32 s57, s43, 13
    s_add_u32 s56, s56, s57
    s_add_u32 s68, s56, 0xc2000
    s_lshl_b32 s56, s48, 15
    s_lshl_b32 s57, s65, 12
    s_add_u32 s56, s56, s57
    s_lshl_b32 s57, s64, 7
    s_add_u32 s56, s56, s57
    s_lshl_b32 s57, s42, 5
    s_add_u32 s56, s56, s57
    s_add_u32 s69, s56, 0xc6000
    s_lshl_b32 s56, s48, 16
    s_lshl_b32 s57, s65, 13
    s_add_u32 s56, s56, s57
    s_lshl_b32 s57, s58, 12
    s_add_u32 s56, s56, s57
    s_lshl_b32 s57, s64, 8
    s_add_u32 s56, s56, s57
    s_lshl_b32 s57, s59, 7
    s_add_u32 s56, s56, s57
    s_add_u32 s71, s56, 0x200000
    s_xor_b32 s58, s43, 1
    s_lshl_b32 s56, s58, 17
    s_lshl_b32 s57, s64, 14
    s_add_u32 s56, s56, s57
    s_lshl_b32 s57, s42, 12
    s_add_u32 s56, s56, s57
    s_add_u32 s70, s56, 0x140000
    s_mov_b32 s51, 0
    s_waitcnt lgkmcnt(0)
    s_add_u32 s74, s74, 1
    s_addc_u32 s75, s75, 0
    s_lshr_b64 s[56:57], s[74:75], 0
    s_and_b32 s57, s56, 0x4000
    s_and_b32 s56, s56, 0x3fff
    s_lshl_b32 s57, s57, 1
    s_or_b32 s60, s56, s57
    s_lshr_b64 s[56:57], s[74:75], 15
    s_and_b32 s57, s56, 0x4000
    s_and_b32 s56, s56, 0x3fff
    s_lshl_b32 s57, s57, 1
    s_or_b32 s61, s56, s57
    s_lshr_b64 s[56:57], s[74:75], 30
    s_and_b32 s57, s56, 0x4000
    s_and_b32 s56, s56, 0x3fff
    s_lshl_b32 s57, s57, 1
    s_or_b32 s62, s56, s57
    s_lshr_b64 s[56:57], s[74:75], 45
    s_and_b32 s57, s56, 0x4000
    s_and_b32 s56, s56, 0x3fff
    s_lshl_b32 s57, s57, 1
    s_or_b32 s63, s56, s57
    s_cmp_lg_u32 s43, 0
    s_cbranch_scc1 L_pq_b0
    s_mov_b32 s44, s36
    s_mov_b32 s45, s37
    s_mov_b32 s46, 0x1000
    s_mov_b32 s47, 0x00020000
    s_waitcnt vmcnt(0)
    v_perm_b32 v20, v54, v52, s53
    v_perm_b32 v21, v58, v56, s53
    v_perm_b32 v22, v62, v60, s53
    v_perm_b32 v23, v66, v64, s53
    v_perm_b32 v24, v54, v52, s54
    v_perm_b32 v25, v58, v56, s54
    v_perm_b32 v26, v62, v60, s54
    v_perm_b32 v27, v66, v64, s54
    v_perm_b32 v28, v55, v53, s53
    v_perm_b32 v29, v59, v57, s53
    v_perm_b32 v30, v63, v61, s53
    v_perm_b32 v31, v67, v65, s53
    v_perm_b32 v32, v55, v53, s54
    v_perm_b32 v33, v59, v57, s54
    v_perm_b32 v34, v63, v61, s54
    v_perm_b32 v35, v67, v65, s54
    v_perm_b32 v36, v70, v68, s53
    v_perm_b32 v37, v74, v72, s53
    v_perm_b32 v38, v78, v76, s53
    v_perm_b32 v39, v82, v80, s53
    v_perm_b32 v40, v70, v68, s54
    v_perm_b32 v41, v74, v72, s54
    v_perm_b32 v42, v78, v76, s54
    v_perm_b32 v43, v82, v80, s54
    v_perm_b32 v44, v71, v69, s53
    v_perm_b32 v45, v75, v73, s53
    v_perm_b32 v46, v79, v77, s53
    v_perm_b32 v47, v83, v81, s53
    v_perm_b32 v48, v71, v69, s54
    v_perm_b32 v49, v75, v73, s54
    v_perm_b32 v50, v79, v77, s54
    v_perm_b32 v51, v83, v81, s54
    s_branch L_pq_mm
L_pq_b0:
    s_waitcnt vmcnt(0)
    v_lshlrev_b32 v100, 16, v96
    v_and_b32 v101, 0xffff0000, v96
    v_lshlrev_b32 v102, 16, v97
    v_and_b32 v103, 0xffff0000, v97
    v_lshlrev_b32 v104, 16, v98
    v_and_b32 v105, 0xffff0000, v98
    v_lshlrev_b32 v106, 16, v99
    v_and_b32 v107, 0xffff0000, v99
    v_pk_add_f32 v[96:97], v[100:101], v[102:103]
    v_pk_add_f32 v[98:99], v[104:105], v[106:107]
    v_pk_add_f32 v[96:97], v[96:97], v[98:99]
    v_add_f32 v96, v96, v97
    s_nop 1
    v_add_f32_dpp v96, v96, v96 row_ror:8 row_mask:0xf bank_mask:0xf
    s_nop 1
    v_add_f32_dpp v96, v96, v96 row_ror:4 row_mask:0xf bank_mask:0xf
    s_nop 1
    v_add_f32_dpp v96, v96, v96 row_ror:2 row_mask:0xf bank_mask:0xf
    s_nop 1
    v_add_f32_dpp v96, v96, v96 row_ror:1 row_mask:0xf bank_mask:0xf
    v_mov_b32 v1, v96
    s_nop 1
    v_permlane32_swap_b32 v96, v1
    v_add_f32 v96, v96, v1
    v_mov_b32 v1, v96
    s_nop 1
    v_permlane16_swap_b32 v96, v1
    v_add_f32 v96, v96, v1
    v_mul_f32 v96, 0x3b000000, v96
    v_pk_add_f32 v[100:101], v[100:101], v[96:97] op_sel_hi:[1,0] neg_lo:[0,1] neg_hi:[0,1]
    v_pk_add_f32 v[102:103], v[102:103], v[96:97] op_sel_hi:[1,0] neg_lo:[0,1] neg_hi:[0,1]
    v_pk_add_f32 v[104:105], v[104:105], v[96:97] op_sel_hi:[1,0] neg_lo:[0,1] neg_hi:[0,1]
    v_pk_add_f32 v[106:107], v[106:107], v[96:97] op_sel_hi:[1,0] neg_lo:[0,1] neg_hi:[0,1]
    v_pk_mul_f32 v[98:99], v[100:101], v[100:101]
    v_pk_fma_f32 v[98:99], v[102:103], v[102:103], v[98:99]
    v_pk_fma_f32 v[98:99], v[104:105], v[104:105], v[98:99]
    v_pk_fma_f32 v[98:99], v[106:107], v[106:107], v[98:99]
    v_add_f32 v97, v98, v99
    s_nop 1
    v_add_f32_dpp v97, v97, v97 row_ror:8 row_mask:0xf bank_mask:0xf
    s_nop 1
    v_add_f32_dpp v97, v97, v97 row_ror:4 row_mask:0xf bank_mask:0xf
    s_nop 1
    v_add_f32_dpp v97, v97, v97 row_ror:2 row_mask:0xf bank_mask:0xf
    s_nop 1
    v_add_f32_dpp v97, v97, v97 row_ror:1 row_mask:0xf bank_mask:0xf
    v_mov_b32 v1, v97
    s_nop 1
    v_permlane32_swap_b32 v97, v1
    v_add_f32 v97, v97, v1
    v_mov_b32 v1, v97
    s_nop 1
    v_permlane16_swap_b32 v97, v1
    v_add_f32 v97, v97, v1
    v_mul_f32 v97, 0x3b000000, v97
    v_add_f32 v97, 0x3727c5ac, v97
    v_rsq_f32 v97, v97
    v_lshlrev_b32 v1, 1, v14
    ds_write_b64 v1, v[96:97] offset:384
    ds_write_b32 v14, v0 offset:128
    v_lshlrev_b32 v116, 16, v116
    v_lshlrev_b32 v117, 16, v117
    v_lshlrev_b32 v118, 16, v118
    v_lshlrev_b32 v119, 16, v119
    ds_read_b128 v[92:95], v13 offset:128
    ds_read_b64 v[96:97], v5 offset:384
    s_waitcnt lgkmcnt(1)
    v_min3_u32 v92, v92, v93, v94
    v_min_u32 v92, v92, v95
    v_cmp_gt_u32 vcc, s50, v92
    s_cbranch_vccnz LXS_40
LXD_39:
    s_waitcnt lgkmcnt(0)
    v_pk_add_f32 v[100:101], v[116:117], v[96:97] op_sel_hi:[1,0] neg_lo:[0,1] neg_hi:[0,1]
    v_pk_mul_f32 v[100:101], v[100:101], v[96:97] op_sel:[0,1] op_sel_hi:[1,1]
    v_pk_add_f32 v[102:103], v[118:119], v[96:97] op_sel_hi:[1,0] neg_lo:[0,1] neg_hi:[0,1]
    v_pk_mul_f32 v[102:103], v[102:103], v[96:97] op_sel:[0,1] op_sel_hi:[1,1]
    v_cvt_pk_bf16_f32 v112, v100, v101
    v_cvt_pk_bf16_f32 v113, v102, v103
    ds_write_b64 v9, v[112:113] offset:3072
    ds_write_b128 v17, v[116:119] offset:4096
    ds_write_b32 v14, v0 offset:0
    s_setprio 0
LW_41:
    ds_read_b32 v1, v13 offset:252
    s_waitcnt lgkmcnt(0)
    v_cmp_gt_u32 vcc, 1, v1
    s_cbranch_vccnz ST_42
    s_sleep 4
    s_mov_b32 s59, s66
    buffer_load_dwordx2 v[52:53], v6, s[8:11], s59 offen nt
    s_add_u32 s59, s59, 16384
    buffer_load_dwordx2 v[68:69], v6, s[8:11], s59 offen nt
    s_add_u32 s59, s59, 49152
    buffer_load_dwordx2 v[54:55], v6, s[8:11], s59 offen nt
    s_add_u32 s59, s59, 16384
    buffer_load_dwordx2 v[70:71], v6, s[8:11], s59 offen nt
    s_add_u32 s59, s59, 49152
    buffer_load_dwordx2 v[56:57], v6, s[8:11], s59 offen nt
    s_add_u32 s59, s59, 16384
    buffer_load_dwordx2 v[72:73], v6, s[8:11], s59 offen nt
    s_add_u32 s59, s59, 49152
    buffer_load_dwordx2 v[58:59], v6, s[8:11], s59 offen nt
    s_add_u32 s59, s59, 16384
    buffer_load_dwordx2 v[74:75], v6, s[8:11], s59 offen nt
    s_add_u32 s59, s59, 49152
    buffer_load_dwordx2 v[60:61], v6, s[8:11], s59 offen nt
    s_add_u32 s59, s59, 16384
    buffer_load_dwordx2 v[76:77], v6, s[8:11], s59 offen nt
    s_add_u32 s59, s59, 49152
    buffer_load_dwordx2 v[62:63], v6, s[8:11], s59 offen nt
    s_add_u32 s59, s59, 16384
    buffer_load_dwordx2 v[78:79], v6, s[8:11], s59 offen nt
    s_add_u32 s59, s59, 49152
    buffer_load_dwordx2 v[64:65], v6, s[8:11], s59 offen nt
    s_add_u32 s59, s59, 16384
    buffer_load_dwordx2 v[80:81], v6, s[8:11], s59 offen nt
    s_add_u32 s59, s59, 49152
    buffer_load_dwordx2 v[66:67], v6, s[8:11], s59 offen nt
    s_add_u32 s59, s59, 16384
    buffer_load_dwordx2 v[82:83], v6, s[8:11], s59 offen nt
    s_waitcnt vmcnt(0)
    v_perm_b32 v20, v54, v52, s53
    v_perm_b32 v21, v58, v56, s53
    v_perm_b32 v22, v62, v60, s53
    v_perm_b32 v23, v66, v64, s53
    v_perm_b32 v24, v54, v52, s54
    v_perm_b32 v25, v58, v56, s54
    v_perm_b32 v26, v62, v60, s54
    v_perm_b32 v27, v66, v64, s54
    v_perm_b32 v28, v55, v53, s53
    v_perm_b32 v29, v59, v57, s53
    v_perm_b32 v30, v63, v61, s53
    v_perm_b32 v31, v67, v65, s53
    v_perm_b32 v32, v55, v53, s54
    v_perm_b32 v33, v59, v57, s54
    v_perm_b32 v34, v63, v61, s54
    v_perm_b32 v35, v67, v65, s54
    v_perm_b32 v36, v70, v68, s53
    v_perm_b32 v37, v74, v72, s53
    v_perm_b32 v38, v78, v76, s53
    v_perm_b32 v39, v82, v80, s53
    v_perm_b32 v40, v70, v68, s54
    v_perm_b32 v41, v74, v72, s54
    v_perm_b32 v42, v78, v76, s54
    v_perm_b32 v43, v82, v80, s54
    v_perm_b32 v44, v71, v69, s53
    v_perm_b32 v45, v75, v73, s53
    v_perm_b32 v46, v79, v77, s53
    v_perm_b32 v47, v83, v81, s53
    v_perm_b32 v48, v71, v69, s54
    v_perm_b32 v49, v75, v73, s54
    v_perm_b32 v50, v79, v77, s54
    v_perm_b32 v51, v83, v81, s54
    s_mov_b32 s50, 0
    s_branch L_pq_cs
L_pq_loop:
    s_setprio 0
    v_mov_b32 v0, s50
    s_sub_u32 s58, s50, 1
    s_lshr_b32 s51, s50, 2
LW_43:
    ds_read_b32 v1, v14 offset:48
    s_waitcnt lgkmcnt(0)
    v_cmp_gt_u32 vcc, s58, v1
    s_cbranch_vccnz ST_44
    s_setprio 3
    ds_read_b128 v[116:119], v17 offset:4096
    s_cmp_lg_u32 s50, 2
    s_cbranch_scc1 LD_45
    s_sleep 1
LD_45:
    s_cmp_lg_u32 s50, 3
    s_cbranch_scc1 LD_46
    s_sleep 8
LD_46:
    s_cmp_lg_u32 s50, 4
    s_cbranch_scc1 LD_47
    s_sleep 1
LD_47:
    s_sleep 7
    s_waitcnt lgkmcnt(0)
    v_pk_mul_f32 v[112:113], v[116:117], 0.5 op_sel_hi:[1,0]
    v_pk_mul_f32 v[114:115], v[118:119], 0.5 op_sel_hi:[1,0]
LP_48:
    buffer_load_dwordx4 v[52:55], v4, s[4:7], s70 offen offset:0 sc1
    buffer_load_dwordx4 v[56:59], v4, s[4:7], s70 offen offset:1024 sc1
    buffer_load_dwordx4 v[60:63], v4, s[4:7], s70 offen offset:2048 sc1
    buffer_load_dwordx4 v[64:67], v4, s[4:7], s70 offen offset:3072 sc1
    s_mov_b64 exec, -1
    s_waitcnt vmcnt(3)
    v_mfma_f32_16x16x32_bf16 v[84:87], v[120:123], v[52:55], v[112:115]
    s_waitcnt vmcnt(2)
    v_mfma_f32_16x16x32_bf16 v[84:87], v[120:123], v[56:59], v[84:87]
    s_waitcnt vmcnt(1)
    v_mfma_f32_16x16x32_bf16 v[84:87], v[120:123], v[60:63], v[84:87]
    s_waitcnt vmcnt(0)
    v_mfma_f32_16x16x32_bf16 v[84:87], v[120:123], v[64:67], v[84:87]
    v_bitop3_b32 v1, v52, v56, 0 bitop3:0x7e
    v_bitop3_b32 v2, v60, v64, 0 bitop3:0x7e
    v_bitop3_b32 v1, v1, v2, 1 bitop3:0xa8
    v_cmp_ne_u32 vcc, 0, v1
    s_cbranch_vccnz ST_49
    s_add_u32 s70, s70, 0x40000
    s_nop 1
    v_add_f32_dpp v116, v84, v84 row_ror:8 row_mask:0xf bank_mask:0xf
    v_add_f32_dpp v117, v85, v85 row_ror:8 row_mask:0xf bank_mask:0xf
    v_add_f32_dpp v118, v86, v86 row_ror:8 row_mask:0xf bank_mask:0xf
    v_add_f32_dpp v119, v87, v87 row_ror:8 row_mask:0xf bank_mask:0xf
    v_cvt_pk_bf16_f32 v112, v116, v117
    v_cvt_pk_bf16_f32 v113, v118, v119
    s_cmp_eq_u32 s50, 5
    s_cbranch_scc1 L_pq_final
    ds_write_b64 v9, v[112:113] offset:3072
    ds_write_b32 v14, v0 offset:0
L_pq_mm:
    ds_read_b128 v[92:95], v13 offset:0
    ds_read_b128 v[84:87], v10 offset:3072
    ds_read_b128 v[88:91], v10 offset:3136
    s_cmp_eq_u32 s50, 1
    s_cbranch_scc1 LNS_52
    s_cmp_eq_u32 s55, 0
    v_pk_add_f32 v[124:125], v[116:117], v[118:119]
    v_pk_mul_f32 v[126:127], v[116:117], v[116:117]
    v_pk_fma_f32 v[126:127], v[118:119], v[118:119], v[126:127]
    v_add_f32 v114, v124, v125
    v_add_f32 v115, v126, v127
    v_bfi_b32 v115, 1, s50, v115
    s_cbranch_scc1 ST_54
    buffer_store_dwordx2 v[114:115], v8, s[4:7], s69 offen
LSD_53:
LNS_52:
    s_waitcnt lgkmcnt(2)
    v_min3_u32 v92, v92, v93, v94
    v_min_u32 v92, v92, v95
    v_cmp_gt_u32 vcc, s50, v92
    s_cbranch_vccnz LXS_51
LXD_50:
    s_waitcnt lgkmcnt(0)
    v_mfma_f32_16x16x32_bf16 v[96:99], v[84:87], v[20:23], 0
    v_mfma_f32_16x16x32_bf16 v[100:103], v[84:87], v[24:27], 0
    v_mfma_f32_16x16x32_bf16 v[96:99], v[88:91], v[36:39], v[96:99]
    v_mfma_f32_16x16x32_bf16 v[100:103], v[88:91], v[40:43], v[100:103]
    v_mfma_f32_16x16x32_bf16 v[104:107], v[84:87], v[28:31], 0
    v_mfma_f32_16x16x32_bf16 v[108:111], v[84:87], v[32:35], 0
    v_mfma_f32_16x16x32_bf16 v[104:107], v[88:91], v[44:47], v[104:107]
    v_mfma_f32_16x16x32_bf16 v[108:111], v[88:91], v[48:51], v[108:111]
    s_cmp_eq_u32 s50, 1
    s_cbranch_scc1 L_pq_pub1
    s_cmp_eq_u32 s55, 0
    s_nop 0
    v_cvt_pk_bf16_f32 v2, v96, v100
    v_bfi_b32 v2, v15, s50, v2
    s_nop 1
    v_cvt_pk_bf16_f32 v3, v104, v108
    s_cbranch_scc1 ST_56
    buffer_store_dwordx2 v[2:3], v7, s[4:7], s67 offen
LSD_55:
    ds_write_b128 v17, v[116:119] offset:4096
    s_branch L_pq_next
L_pq_pub1:
    s_nop 1
    v_cvt_pk_bf16_f32 v2, v96, v100
    s_nop 2
    v_cvt_pk_bf16_f32 v3, v104, v108
    s_mov_b32 s56, 0xffff0000
    v_mov_b32 v124, s60
    v_mov_b32 v125, s61
    v_mov_b32 v126, s62
    v_mov_b32 v127, s63
    v_lshl_or_b32 v124, v2, 16, v124
    v_and_or_b32 v125, v2, s56, v125
    v_lshl_or_b32 v126, v3, 16, v126
    v_and_or_b32 v127, v3, s56, v127
    buffer_store_dwordx4 v[124:127], v16, s[4:7], s71 offen
    ds_write_b32 v14, v0 offset:352
LW_57:
    ds_read_b32 v1, v13 offset:240
    s_waitcnt lgkmcnt(0)
    v_cmp_gt_u32 vcc, 1, v1
    s_cbranch_vccnz ST_58
    v_readfirstlane_b32 s55, v1
    s_lshr_b32 s55, s55, 1
    s_cmp_lg_u32 s55, 0
    s_cbranch_scc1 L_pq_cs
    buffer_store_dwordx4 v[124:127], v16, s[4:7], s71 offen sc1
L_pq_cs:
    v_mov_b32 v112, 0x3f803f80
    v_mov_b32 v113, 0x3f803f80
    v_mov_b32 v114, 0x3f803f80
    v_mov_b32 v115, 0x3f803f80
    s_nop 1
    v_mfma_f32_16x16x32_bf16 v[96:99], v[112:115], v[20:23], 0
    v_mfma_f32_16x16x32_bf16 v[100:103], v[112:115], v[24:27], 0
    v_mfma_f32_16x16x32_bf16 v[104:107], v[112:115], v[28:31], 0
    v_mfma_f32_16x16x32_bf16 v[108:111], v[112:115], v[32:35], 0
    v_mfma_f32_16x16x32_bf16 v[96:99], v[112:115], v[36:39], v[96:99]
    v_mfma_f32_16x16x32_bf16 v[100:103], v[112:115], v[40:43], v[100:103]
    v_mfma_f32_16x16x32_bf16 v[104:107], v[112:115], v[44:47], v[104:107]
    v_mfma_f32_16x16x32_bf16 v[108:111], v[112:115], v[48:51], v[108:111]
    s_nop 5
    v_cvt_pk_bf16_f32 v2, v96, v100
    s_nop 0
    v_cvt_pk_bf16_f32 v3, v104, v108
    v_bfi_b32 v2, v15, 0, v2
LW_59:
    ds_read_b32 v1, v13 offset:240
    s_waitcnt lgkmcnt(0)
    v_cmp_gt_u32 vcc, 1, v1
    s_cbranch_vccnz ST_60
    v_readfirstlane_b32 s55, v1
    s_lshr_b32 s55, s55, 1
    s_cmp_eq_u32 s55, 0
    s_cbranch_scc1 ST_62
    buffer_store_dwordx2 v[2:3], v12, s[4:7], s68 offen
LSD_61:
LW_63:
    ds_read_b32 v1, v13 offset:244
    s_waitcnt lgkmcnt(0)
    v_cmp_gt_u32 vcc, 1, v1
    s_cbranch_vccnz ST_64
L_pq_next:
    s_add_u32 s50, s50, 2
    s_cmp_le_u32 s50, 4
    s_nop 1
    s_cbranch_scc1 L_pq_loop
    s_or_b32 s56, s48, s65
    s_or_b32 s56, s56, s43
    s_cmp_eq_u32 s56, 0
    s_cbranch_scc1 L_pq_loop
    s_branch L_end
L_pq_final:
    buffer_store_short v112, v11, s[44:47], s72 offen
    buffer_store_short_d16_hi v112, v11, s[44:47], s72 offen offset:16
    buffer_store_short v113, v11, s[44:47], s72 offen offset:32
    buffer_store_short_d16_hi v113, v11, s[44:47], s72 offen offset:48
    s_branch L_end
L_PO:
    s_and_b32 s51, s43, 1
    s_add_u32 s56, s40, 0x2f0000
    s_addc_u32 s57, s41, 0
    s_load_dwordx2 s[74:75], s[56:57], 0
    s_add_u32 s50, s51, 1
    s_lshr_b32 s64, s73, 2
    s_and_b32 s65, s73, 3
    s_lshl_b32 s60, s48, 2
    s_add_u32 s60, s60, s64
    s_cmp_lg_u32 s51, 0
    s_cselect_b32 s8, s34, s24
    s_cselect_b32 s9, s35, s25
    s_mov_b32 s10, 0x400000
    s_mov_b32 s11, 0x00020000
    s_lshl_b32 s56, s60, 17
    s_lshl_b32 s57, s42, 11
    s_add_u32 s56, s56, s57
    s_lshl_b32 s57, s65, 8
    s_add_u32 s56, s56, s57
    s_add_u32 s66, s56, 0x0
    v_lshlrev_b32 v16, 4, v2
    v_lshl_add_u32 v6, v3, 15, v16
    s_lshl_b32 s56, s60, 13
    s_lshl_b32 s57, s42, 11
    s_add_u32 s56, s56, s57
    s_add_u32 s68, s56, 0x80000
    v_and_b32 v17, 3, v2
    s_lshl_b32 s56, s48, 15
    s_lshl_b32 s57, s64, 10
    s_add_u32 s56, s56, s57
    s_lshl_b32 s57, s42, 8
    s_add_u32 s56, s56, s57
    s_add_u32 s69, s56, 0xc0000
    v_lshlrev_b32 v7, 4, v2
    s_lshl_b32 s56, s51, 17
    s_lshl_b32 s57, s65, 15
    s_add_u32 s56, s56, s57
    s_lshl_b32 s57, s42, 13
    s_add_u32 s56, s56, s57
    s_lshl_b32 s57, s60, 7
    s_add_u32 s56, s56, s57
    s_add_u32 s70, s56, 0x140000
    v_lshlrev_b32 v16, 3, v3
    v_lshl_add_u32 v16, v2, 3, v16
    v_mov_b32 v18, 0x40000000
    v_cmp_eq_u32 vcc, 0, v17
    s_nop 1
    v_cndmask_b32 v8, v18, v16, vcc
    v_and_b32 v17, 1, v3
    v_or_b32 v11, -2, v17
    v_lshlrev_b32 v17, 3, v17
    v_lshl_add_u32 v17, v2, 4, v17
    s_mul_i32 s56, s42, 320
    v_add_u32 v9, s56, v17
    v_lshrrev_b32 v16, 2, v2
    v_lshlrev_b32 v17, 4, v3
    v_lshl_add_u32 v10, v16, 8, v17
    v_lshl_add_u32 v10, v16, 6, v10
    s_lshl_b32 s56, s51, 15
    s_lshl_b32 s57, s42, 13
    s_add_u32 s56, s56, s57
    s_add_u32 s58, s56, 0x4000
    v_add_u32 v12, s58, v4
    s_lshl_b32 s56, s51, 15
    s_lshl_b32 s57, s42, 11
    s_add_u32 s56, s56, s57
    s_add_u32 s58, s56, 0x4000
    v_add_u32 v15, s58, v4
    s_lshl_b32 s56, s51, 4
    v_mov_b32 v126, s56
    v_add_u32 v5, s56, v14
    v_and_b32 v16, 1, v1
    v_lshlrev_b32 v16, 4, v16
    v_mov_b32 v17, 0xffff
    v_lshlrev_b32 v16, v16, v17
    v_bfe_u32 v17, v1, 1, 2
    v_cmp_eq_u32 vcc, 0, v17
    s_nop 1
    v_cndmask_b32 v84, v13, v16, vcc
    v_cmp_eq_u32 vcc, 1, v17
    s_nop 1
    v_cndmask_b32 v85, v13, v16, vcc
    v_cmp_eq_u32 vcc, 2, v17
    s_nop 1
    v_cndmask_b32 v86, v13, v16, vcc
    v_cmp_eq_u32 vcc, 3, v17
    s_nop 1
    v_cndmask_b32 v87, v13, v16, vcc
    s_mov_b32 s71, 0x01000100
    s_mov_b32 s72, 0x03020302
    v_mov_b32 v0, 1
    s_cmp_lg_u32 s51, 0
    s_cbranch_scc1 L_po_gb
    s_cmp_lg_u32 s42, 0
    s_cbranch_scc1 L_po_ga
    s_waitcnt lgkmcnt(0)
    s_add_u32 s74, s74, 1
    s_addc_u32 s75, s75, 0
    s_lshl_b32 s56, s48, 12
    s_lshl_b32 s57, s49, 7
    s_add_u32 s56, s56, s57
    s_add_u32 s58, s56, 0x2b0080
    s_mov_b32 s59, 40
L_po_bg:
    buffer_load_dwordx2 v[16:17], v13, s[4:7], s58 offen sc1
    s_waitcnt vmcnt(0)
    v_xor_b32 v16, s74, v16
    v_bitop3_b32 v16, v16, v17, s75 bitop3:0xf6
    v_cmp_ne_u32 vcc, 0, v16
    s_cbranch_vccz L_po_bgd
    s_sleep 2
    s_sub_u32 s59, s59, 1
    s_cbranch_scc0 L_po_bg
L_po_bgd:
LX_65:
    ds_read_b128 v[16:19], v13 offset:352
    s_waitcnt lgkmcnt(0)
    v_min3_u32 v16, v16, v17, v18
    v_min_u32 v16, v16, v19
    v_cmp_gt_u32 vcc, 1, v16
    s_cbranch_vccnz ST_66
    ds_write_b32 v13, v0 offset:252
L_po_ga:
LW_67:
    ds_read_b32 v16, v13 offset:252
    s_waitcnt lgkmcnt(0)
    v_cmp_gt_u32 vcc, 1, v16
    s_cbranch_vccnz ST_68
    s_setprio 2
    s_branch L_po_ld
L_po_gb:
LW_69:
    ds_read_b32 v16, v14 offset:0
    s_waitcnt lgkmcnt(0)
    v_cmp_gt_u32 vcc, 2, v16
    s_cbranch_vccnz ST_70
    s_sleep 12
L_po_ld:
    s_mov_b32 s59, s66
    buffer_load_dwordx4 v[48:51], v6, s[8:11], s59 offen offset:0 nt
    buffer_load_dwordx4 v[52:55], v6, s[8:11], s59 offen offset:1024 nt
    s_add_u32 s59, s59, 8192
    buffer_load_dwordx4 v[56:59], v6, s[8:11], s59 offen offset:0 nt
    buffer_load_dwordx4 v[60:63], v6, s[8:11], s59 offen offset:1024 nt
    s_add_u32 s59, s59, 8192
    buffer_load_dwordx4 v[64:67], v6, s[8:11], s59 offen offset:0 nt
    buffer_load_dwordx4 v[68:71], v6, s[8:11], s59 offen offset:1024 nt
    s_add_u32 s59, s59, 8192
    buffer_load_dwordx4 v[72:75], v6, s[8:11], s59 offen offset:0 nt
    buffer_load_dwordx4 v[76:79], v6, s[8:11], s59 offen offset:1024 nt
    s_waitcnt vmcnt(0)
    v_perm_b32 v16, v52, v48, s53
    v_perm_b32 v17, v60, v56, s53
    v_perm_b32 v18, v68, v64, s53
    v_perm_b32 v19, v76, v72, s53
    v_perm_b32 v20, v52, v48, s54
    v_perm_b32 v21, v60, v56, s54
    v_perm_b32 v22, v68, v64, s54
    v_perm_b32 v23, v76, v72, s54
    v_perm_b32 v24, v53, v49, s53
    v_perm_b32 v25, v61, v57, s53
    v_perm_b32 v26, v69, v65, s53
    v_perm_b32 v27, v77, v73, s53
    v_perm_b32 v28, v53, v49, s54
    v_perm_b32 v29, v61, v57, s54
    v_perm_b32 v30, v69, v65, s54
    v_perm_b32 v31, v77, v73, s54
    v_perm_b32 v32, v54, v50, s53
    v_perm_b32 v33, v62, v58, s53
    v_perm_b32 v34, v70, v66, s53
    v_perm_b32 v35, v78, v74, s53
    v_perm_b32 v36, v54, v50, s54
    v_perm_b32 v37, v62, v58, s54
    v_perm_b32 v38, v70, v66, s54
    v_perm_b32 v39, v78, v74, s54
    v_perm_b32 v40, v55, v51, s53
    v_perm_b32 v41, v63, v59, s53
    v_perm_b32 v42, v71, v67, s53
    v_perm_b32 v43, v79, v75, s53
    v_perm_b32 v44, v55, v51, s54
    v_perm_b32 v45, v63, v59, s54
    v_perm_b32 v46, v71, v67, s54
    v_perm_b32 v47, v79, v75, s54
    ds_write_b128 v12, v[16:19] offset:0
    ds_write_b128 v12, v[20:23] offset:1024
    ds_write_b128 v12, v[24:27] offset:2048
    ds_write_b128 v12, v[28:31] offset:3072
    ds_write_b128 v12, v[32:35] offset:4096
    ds_write_b128 v12, v[36:39] offset:5120
    ds_write_b128 v12, v[40:43] offset:6144
    ds_write_b128 v12, v[44:47] offset:7168
    ds_write_b32 v5, v0 offset:96
LX_71:
    ds_read_b128 v[64:67], v126 offset:96
    s_waitcnt lgkmcnt(0)
    v_min3_u32 v64, v64, v65, v66
    v_min_u32 v64, v64, v67
    v_cmp_gt_u32 vcc, 1, v64
    s_cbranch_vccnz ST_72
    ds_read_b128 v[16:19], v15 offset:0
    ds_read_b128 v[20:23], v15 offset:1024
    ds_read_b128 v[24:27], v15 offset:8192
    ds_read_b128 v[28:31], v15 offset:9216
    ds_read_b128 v[32:35], v15 offset:16384
    ds_read_b128 v[36:39], v15 offset:17408
    ds_read_b128 v[40:43], v15 offset:24576
    ds_read_b128 v[44:47], v15 offset:25600
LW_73:
    ds_read_b32 v1, v13 offset:240
    s_waitcnt lgkmcnt(0)
    v_cmp_gt_u32 vcc, 1, v1
    s_cbranch_vccnz ST_74
L_po_loop:
    s_setprio 0
    v_mov_b32 v0, s50
    s_add_u32 s59, s70, 4096
LW_75:
    ds_read_b32 v1, v14 offset:0
    s_waitcnt lgkmcnt(0)
    v_cmp_gt_u32 vcc, s50, v1
    s_cbranch_vccnz ST_76
    s_cmp_lt_u32 s50, 3
    s_cbranch_scc1 LZ_77
    s_sleep 22
LZ_77:
LP_78:
    buffer_load_dwordx4 v[80:83], v7, s[4:7], s69 offen sc1
    s_cmp_gt_u32 s50, 1
    s_cbranch_scc1 LE_79
    buffer_load_dwordx4 v[68:71], v4, s[4:7], s68 offen offset:0 sc1
    buffer_load_dwordx4 v[72:75], v4, s[4:7], s68 offen offset:1024 sc1
LE_79:
    s_waitcnt vmcnt(0)
    v_bitop3_b32 v1, v81, v83, s51 bitop3:0x7e
    v_and_b32 v1, 1, v1
    v_cmp_ne_u32 vcc, 0, v1
    s_cbranch_vccnz ST_81
    s_cbranch_scc0 LE_82
    buffer_load_dwordx4 v[68:71], v4, s[4:7], s68 offen offset:0 sc1
    buffer_load_dwordx4 v[72:75], v4, s[4:7], s68 offen offset:1024 sc1
LE_82:
    s_setprio 3
    v_max_f32_dpp v108, v80, v80 row_ror:4 row_mask:0xf bank_mask:0xf
    v_max_f32_dpp v109, v82, v82 row_ror:4 row_mask:0xf bank_mask:0xf
    s_nop 0
    v_max_f32_dpp v108, v108, v108 row_ror:8 row_mask:0xf bank_mask:0xf
    v_max_f32_dpp v109, v109, v109 row_ror:8 row_mask:0xf bank_mask:0xf
    v_max_f32 v2, v108, v109
    s_nop 1
    v_max_f32_dpp v2, v2, v2 quad_perm:[1,0,3,2] row_mask:0xf bank_mask:0xf
    s_nop 1
    v_max_f32_dpp v2, v2, v2 quad_perm:[2,3,0,1] row_mask:0xf bank_mask:0xf
    v_sub_f32 v110, v80, v2
    v_sub_f32 v111, v82, v2
    v_exp_f32 v110, v110
    v_exp_f32 v111, v111
    v_pk_add_f32 v[108:109], v[108:109], v[2:3] op_sel_hi:[1,0] neg_lo:[0,1] neg_hi:[0,1]
    v_mul_f32 v1, v110, v81
    v_fmac_f32 v1, v111, v83
    v_exp_f32 v108, v108
    v_exp_f32 v109, v109
    v_add_f32_dpp v1, v1, v1 quad_perm:[1,0,3,2] row_mask:0xf bank_mask:0xf
    s_nop 1
    v_add_f32_dpp v1, v1, v1 quad_perm:[2,3,0,1] row_mask:0xf bank_mask:0xf
    s_nop 1
    v_add_f32_dpp v1, v1, v1 row_ror:4 row_mask:0xf bank_mask:0xf
    s_nop 1
    v_add_f32_dpp v1, v1, v1 row_ror:8 row_mask:0xf bank_mask:0xf
    v_rcp_f32 v2, v1
    s_nop 0
    v_pk_mul_f32 v[108:109], v[108:109], v[2:3] op_sel_hi:[1,0]
    v_cvt_pk_bf16_f32 v1, v108, v109
    s_nop 1
    v_mov_b32_dpp v2, v1 quad_perm:[0,0,0,0] row_mask:0x1 bank_mask:0xf
    v_mov_b32_dpp v2, v1 quad_perm:[1,1,1,1] row_mask:0x2 bank_mask:0xf
    v_mov_b32_dpp v2, v1 quad_perm:[2,2,2,2] row_mask:0x4 bank_mask:0xf
    v_mov_b32_dpp v2, v1 quad_perm:[3,3,3,3] row_mask:0x8 bank_mask:0xf
    v_perm_b32 v108, v2, v2, s71
    v_perm_b32 v109, v2, v2, s72
    v_and_b32 v88, v108, v84
    v_and_b32 v89, v108, v85
    v_and_b32 v90, v108, v86
    v_and_b32 v91, v108, v87
    v_and_b32 v92, v109, v84
    v_and_b32 v93, v109, v85
    v_and_b32 v94, v109, v86
    v_and_b32 v95, v109, v87
LO_83:
    s_waitcnt vmcnt(1)
    v_mfma_f32_16x16x32_bf16 v[96:99], v[88:91], v[68:71], 0
    s_waitcnt vmcnt(0)
    v_mfma_f32_16x16x32_bf16 v[96:99], v[92:95], v[72:75], v[96:99]
    v_bitop3_b32 v1, v68, v72, s51 bitop3:0x7e
    v_and_b32 v1, 1, v1
    v_cmp_ne_u32 vcc, 0, v1
    s_cbranch_vccnz ST_84
    s_nop 3
    v_cvt_pk_bf16_f32 v96, v96, v97
    v_cvt_pk_bf16_f32 v97, v98, v99
    ds_write_b64 v9, v[96:97] offset:1024
    ds_write_b32 v14, v0 offset:32
LXF_85:
    ds_read_b128 v[64:67], v13 offset:32
    ds_read_b128 v[48:51], v10 offset:1024
    ds_read_b128 v[52:55], v10 offset:1088
    ds_read_b128 v[56:59], v10 offset:1152
    ds_read_b128 v[60:63], v10 offset:1216
    s_waitcnt lgkmcnt(4)
    v_min3_u32 v64, v64, v65, v66
    v_min_u32 v64, v64, v67
    v_cmp_gt_u32 vcc, s50, v64
    s_cbranch_vccnz ST_86
    s_waitcnt lgkmcnt(0)
    v_mfma_f32_16x16x32_bf16 v[100:103], v[16:19], v[48:51], 0
    v_mfma_f32_16x16x32_bf16 v[100:103], v[24:27], v[52:55], v[100:103]
    v_mfma_f32_16x16x32_bf16 v[100:103], v[32:35], v[56:59], v[100:103]
    v_mfma_f32_16x16x32_bf16 v[100:103], v[40:43], v[60:63], v[100:103]
    v_mfma_f32_16x16x32_bf16 v[104:107], v[20:23], v[48:51], 0
    v_mfma_f32_16x16x32_bf16 v[104:107], v[28:31], v[52:55], v[104:107]
    v_mfma_f32_16x16x32_bf16 v[104:107], v[36:39], v[56:59], v[104:107]
    v_mfma_f32_16x16x32_bf16 v[104:107], v[44:47], v[60:63], v[104:107]
    s_nop 3
    v_cvt_pk_bf16_f32 v100, v100, v101
    v_cvt_pk_bf16_f32 v101, v102, v103
    v_and_b32 v100, v11, v100
    buffer_store_dwordx2 v[100:101], v8, s[4:7], s70 offen sc1
    v_cvt_pk_bf16_f32 v104, v104, v105
    v_cvt_pk_bf16_f32 v105, v106, v107
    v_and_b32 v104, v11, v104
    buffer_store_dwordx2 v[104:105], v8, s[4:7], s59 offen sc1
    ds_write_b32 v14, v0 offset:48
    s_add_u32 s70, s70, 0x40000
    s_add_u32 s50, s50, 2
    s_cmp_le_u32 s50, 4
    s_cbranch_scc1 L_po_loop
    s_branch L_end
ST_2:
    s_sleep 2
    s_sub_u32 s52, s52, 1
    s_cbranch_scc0 LW_1
    s_branch L_end
ST_6:
    s_sleep 1
    s_sub_u32 s52, s52, 1
    s_cbranch_scc0 LW_5
    s_branch L_end
ST_8:
    s_sleep 2
    s_sub_u32 s52, s52, 1
    s_cbranch_scc0 LX_7
    s_branch L_end
ST_10:
    s_sleep 1
    s_sub_u32 s52, s52, 1
    s_cbranch_scc0 LX_9
    s_branch L_end
ST_12:
    s_sleep 1
    s_sub_u32 s52, s52, 1
    s_cbranch_scc0 LX_11
    s_branch L_end
ST_14:
    s_sub_u32 s52, s52, 1
    s_cbranch_scc0 LX_13
    s_branch L_end
ST_16:
    s_sleep 1
    s_sub_u32 s52, s52, 1
    s_cbranch_scc0 LW_15
    s_branch L_end
ST_18:
    s_sleep 1
    s_sub_u32 s52, s52, 1
    s_cbranch_scc0 LW_17
    s_branch L_end
ST_20:
    s_sub_u32 s52, s52, 1
    s_cbranch_scc0 LX_19
    s_branch L_end
ST_24:
    s_nop 7
    buffer_store_dwordx2 v[18:19], v11, s[4:7], s66 offen sc1
    s_branch LSD_23
LXS_22:
    s_sub_u32 s52, s52, 1
    s_cbranch_scc1 L_end
    ds_read_b128 v[84:87], v2 offset:176
    s_waitcnt lgkmcnt(0)
    v_min3_u32 v84, v84, v85, v86
    v_min_u32 v84, v84, v87
    v_cmp_gt_u32 vcc, s50, v84
    s_cbranch_vccnz LXS_22
    ds_read_b128 v[120:123], v17 offset:512
    ds_read_b128 v[116:119], v16 offset:4096
    ds_read_b128 v[104:107], v16 offset:5120
    ds_read_b128 v[108:111], v16 offset:6144
    ds_read_b128 v[112:115], v16 offset:7168
    s_branch LXD_21
ST_26:
    s_nop 7
    buffer_store_dword v126, v10, s[4:7], s65 offen sc1
    s_branch LSD_25
ST_29:
    s_mov_b64 exec, vcc
    s_sleep 4
    s_sub_u32 s52, s52, 1
    s_cbranch_scc0 LP_28
    s_branch L_end
ST_31:
    s_sleep 4
    s_sub_u32 s52, s52, 1
    s_cbranch_scc0 LX_30
    s_branch L_end
ST_33:
    s_sleep 2
    s_sub_u32 s52, s52, 1
    s_cbranch_scc0 LX_32
    s_branch L_end
ST_36:
    s_sub_u32 s52, s52, 1
    s_cbranch_scc1 L_end
    s_cmp_eq_u64 vcc, -1
    s_cbranch_scc0 LPT_35
    s_sleep 2
    s_branch LP_34
LPT_35:
    s_setprio 3
    ds_write_b32 v13, v0 offset:248
    s_mov_b64 exec, vcc
    s_branch LP_34
ST_38:
    s_mov_b64 exec, vcc
    buffer_load_dwordx4 v[84:87], v4, s[4:7], s60 offen offset:0 sc1
    buffer_load_dwordx4 v[88:91], v4, s[4:7], s60 offen offset:1024 sc1
    s_mov_b64 exec, -1
    s_sub_u32 s52, s52, 1
    s_cbranch_scc0 LO_37
    s_branch L_end
LXS_40:
    s_sub_u32 s52, s52, 1
    s_cbranch_scc1 L_end
    ds_read_b128 v[92:95], v13 offset:128
    s_waitcnt lgkmcnt(0)
    v_min3_u32 v92, v92, v93, v94
    v_min_u32 v92, v92, v95
    v_cmp_gt_u32 vcc, s50, v92
    s_cbranch_vccnz LXS_40
    ds_read_b64 v[96:97], v5 offset:384
    s_branch LXD_39
ST_42:
    s_sleep 2
    s_sub_u32 s52, s52, 1
    s_cbranch_scc0 LW_41
    s_branch L_end
ST_44:
    s_sleep 1
    s_sub_u32 s52, s52, 1
    s_cbranch_scc0 LW_43
    s_branch L_end
ST_49:
    s_mov_b64 exec, vcc
    s_nop 4
    s_sub_u32 s52, s52, 1
    s_cbranch_scc0 LP_48
    s_branch L_end
ST_54:
    s_nop 7
    buffer_store_dwordx2 v[114:115], v8, s[4:7], s69 offen sc1
    s_branch LSD_53
LXS_51:
    s_sub_u32 s52, s52, 1
    s_cbranch_scc1 L_end
    ds_read_b128 v[92:95], v13 offset:0
    s_waitcnt lgkmcnt(0)
    v_min3_u32 v92, v92, v93, v94
    v_min_u32 v92, v92, v95
    v_cmp_gt_u32 vcc, s50, v92
    s_cbranch_vccnz LXS_51
    ds_read_b128 v[84:87], v10 offset:3072
    ds_read_b128 v[88:91], v10 offset:3136
    s_branch LXD_50
ST_56:
    s_nop 7
    buffer_store_dwordx2 v[2:3], v7, s[4:7], s67 offen sc1
    s_branch LSD_55
ST_58:
    s_sleep 1
    s_sub_u32 s52, s52, 1
    s_cbranch_scc0 LW_57
    s_branch L_end
ST_60:
    s_sleep 1
    s_sub_u32 s52, s52, 1
    s_cbranch_scc0 LW_59
    s_branch L_end
ST_62:
    s_nop 7
    buffer_store_dwordx2 v[2:3], v12, s[4:7], s68 offen sc1
    s_branch LSD_61
ST_64:
    s_sleep 1
    s_sub_u32 s52, s52, 1
    s_cbranch_scc0 LW_63
    s_branch L_end
ST_66:
    s_sleep 1
    s_sub_u32 s52, s52, 1
    s_cbranch_scc0 LX_65
    s_branch L_end
ST_68:
    s_sleep 1
    s_sub_u32 s52, s52, 1
    s_cbranch_scc0 LW_67
    s_branch L_end
ST_70:
    s_sleep 2
    s_sub_u32 s52, s52, 1
    s_cbranch_scc0 LW_69
    s_branch L_end
ST_72:
    s_sleep 1
    s_sub_u32 s52, s52, 1
    s_cbranch_scc0 LX_71
    s_branch L_end
ST_74:
    s_sleep 1
    s_sub_u32 s52, s52, 1
    s_cbranch_scc0 LW_73
    s_branch L_end
ST_76:
    s_sleep 2
    s_sub_u32 s52, s52, 1
    s_cbranch_scc0 LW_75
    s_branch L_end
ST_81:
    s_sub_u32 s52, s52, 1
    s_cbranch_scc1 L_end
    s_cmp_eq_u64 vcc, -1
    s_cbranch_scc0 LPT_80
    s_sleep 2
    s_branch LP_78
LPT_80:
    s_setprio 3
    s_branch LP_78
ST_84:
    s_mov_b64 exec, vcc
    buffer_load_dwordx4 v[68:71], v4, s[4:7], s68 offen offset:0 sc1
    buffer_load_dwordx4 v[72:75], v4, s[4:7], s68 offen offset:1024 sc1
    s_mov_b64 exec, -1
    s_sub_u32 s52, s52, 1
    s_cbranch_scc0 LO_83
    s_branch L_end
ST_86:
    s_sub_u32 s52, s52, 1
    s_cbranch_scc0 LXF_85
    s_branch L_end
L_end:
L_exit:
    s_endpgm
L_codeend:
.section .rodata,"a"
.p2align 6
.amdhsa_kernel interleave_layers__sliding_block_cached__sliding_block_cached__decode_kernel
  .amdhsa_next_free_vgpr 128
  .amdhsa_next_free_sgpr 102
  .amdhsa_accum_offset 128
  .amdhsa_group_segment_fixed_size 0
  .amdhsa_kernarg_size 104
  .amdhsa_user_sgpr_count 2
  .amdhsa_user_sgpr_kernarg_segment_ptr 1
  .amdhsa_system_sgpr_workgroup_id_x 1
.end_amdhsa_kernel
```
